```python
import torch

def _softmax(x, axis=-1):
    return torch.softmax(x, dim=axis)
def _gelu(x):
    return torch.nn.functional.gelu(x, approximate="tanh")
def _silu(x):
    return torch.nn.functional.silu(x)
def _sigmoid(x):
    return torch.sigmoid(x)
def _layernorm(x, axis=-1, eps=1e-5):
    m = x.mean(dim=axis, keepdim=True)
    v = x.var(dim=axis, keepdim=True, unbiased=False)
    return (x - m) / torch.sqrt(v + eps)
def _scatter_add(tgt, idx, src, axis=0):
    return tgt.clone().index_add_(axis, idx, src)
def _segment_sum(src, seg, n):
    out = torch.zeros((n,) + src.shape[1:], dtype=src.dtype)
    return out.index_add_(0, seg, src)
def _pad(x, pw):
    flat = tuple(v for pair in reversed(pw) for v in pair)
    return torch.nn.functional.pad(x, flat)

kernel_name = 'gated_mix__linear_attn_block__linear_attn_block__prompt'

def setup_inputs():

    _w = (lambda a: (lambda t: t.to(torch.bfloat16) if t.is_floating_point() else t)(torch.as_tensor(a)))
    def _A_setup():
        B, S, D = 1, 2048, 512
        return {
            "x": _w((lambda *s: torch.randn(*s, dtype=torch.bfloat16) * 0.05)(B, S, D)),
            "wqkv": _w((lambda *s: torch.randn(*s, dtype=torch.bfloat16) * 0.8)(D, 3 * D)),
            "wo": _w((lambda *s: torch.randn(*s, dtype=torch.bfloat16) * 0.05)(D, D)),
        }
    _A_in = _A_setup()

    def _B_setup():
        B, S, D = 1, 2048, 512
        return {
            "x": _w((lambda *s: torch.randn(*s, dtype=torch.bfloat16) * 0.05)(B, S, D)),
            "wqkv": _w((lambda *s: torch.randn(*s, dtype=torch.bfloat16) * 0.8)(D, 3 * D)),
            "wo": _w((lambda *s: torch.randn(*s, dtype=torch.bfloat16) * 0.05)(D, D)),
        }
    _B_in = _B_setup()

    return {
        "A_x": _A_in["x"],
        "A_wqkv": _A_in["wqkv"],
        "A_wo": _A_in["wo"],
        "B_x": _B_in["x"],
        "B_wqkv": _B_in["wqkv"],
        "B_wo": _B_in["wo"],
        "gate_w": _w((lambda *s: torch.randn(*s, dtype=torch.bfloat16) * 0.05)(512) * 16.0),
    }

def reference(A_x, A_wqkv, A_wo, B_x, B_wqkv, B_wo, gate_w):
    def _A_ref(x, wqkv, wo):
        B, S, D = x.shape
        H = 32; Dh = D // H
        qkv = (lambda x, *d: x.permute(*d))((x @ wqkv).reshape(B, S, 3, H, Dh), 2, 0, 3, 1, 4)
        q, k, v = qkv[0], qkv[1], qkv[2]
        phi = lambda t: torch.where(t > 0, t + 1, torch.exp(t)) + 1e-6
        pq, pk = phi(q), phi(k)
        kv = torch.einsum("bhsd,bhse->bhde", pk, v)
        z = torch.einsum("bhsd->bhd", pk)
        num = torch.einsum("bhqd,bhde->bhqe", pq, kv)
        den = torch.einsum("bhqd,bhd->bhq", pq, z)[..., None] + 1e-6
        o = num / den
        return (lambda x, *d: x.permute(*d))(o, 0, 2, 1, 3).reshape(B, S, D) @ wo

    def _B_ref(x, wqkv, wo):
        B, S, D = x.shape
        H = 32; Dh = D // H
        qkv = (lambda x, *d: x.permute(*d))((x @ wqkv).reshape(B, S, 3, H, Dh), 2, 0, 3, 1, 4)
        q, k, v = qkv[0], qkv[1], qkv[2]
        phi = lambda t: torch.where(t > 0, t + 1, torch.exp(t)) + 1e-6
        pq, pk = phi(q), phi(k)
        kv = torch.einsum("bhsd,bhse->bhde", pk, v)
        z = torch.einsum("bhsd->bhd", pk)
        num = torch.einsum("bhqd,bhde->bhqe", pq, kv)
        den = torch.einsum("bhqd,bhd->bhq", pq, z)[..., None] + 1e-6
        o = num / den
        return (lambda x, *d: x.permute(*d))(o, 0, 2, 1, 3).reshape(B, S, D) @ wo

    x = A_x
    g = _sigmoid((x * gate_w).sum(-1, keepdims=True))
    a = _A_ref(x, A_wqkv, A_wo)
    b = _B_ref(x, B_wqkv, B_wo)
    return g * a + (1 - g) * b
```

```asm
; @launch grid=(256,1,1) block=(256,1,1) lds=163840
.amdgcn_target "amdgcn-amd-amdhsa--gfx950"
.text
.p2align 12
.fill 832, 4, 0xbf810000
.globl gated_mix__linear_attn_block__linear_attn_block__prompt_kernel
.p2align 8
.type gated_mix__linear_attn_block__linear_attn_block__prompt_kernel,@function
gated_mix__linear_attn_block__linear_attn_block__prompt_kernel:
    s_load_dwordx4 s[4:7], s[0:1], 0
    s_load_dwordx4 s[64:67], s[0:1], 32
    s_load_dwordx4 s[32:35], s[0:1], 48
    s_load_dwordx2 s[16:17], s[0:1], 16
    s_load_dwordx4 s[28:31], s[0:1], 64
    s_memrealtime s[68:69]
    s_cmp_ge_u32 s2, 256
    s_cbranch_scc1 L_end
    v_lshrrev_b32 v192, 6, v0
    s_getpc_b64 s[60:61]
    v_readfirstlane_b32 s3, v192
    s_lshr_b32 s58, s2, 3
    s_lshl_b32 s57, s58, 9
    v_lshl_add_u32 v196, v192, 7, s57
    v_and_b32 v198, 1, v0
    v_lshl_add_u32 v196, v198, 14, v196
    global_load_dword v197, v196, s[60:61]
    v_and_b32 v1, 63, v0
    s_and_b32 s36, s2, 1
    s_lshl_b32 s36, s36, 3
    s_and_b32 s37, s58, 7
    s_add_u32 s36, s36, s37
    v_lshrrev_b32 v192, 3, v1
    v_lshrrev_b32 v193, 4, v1
    v_and_b32 v194, 7, v1
    v_xor_b32 v195, v194, v193
    v_lshlrev_b32 v195, 4, v195
    v_lshl_add_u32 v8, v192, 10, v195
    v_xor_b32 v198, 64, v8
    v_add_u32 v9, 7168, v198
    v_add_u32 v10, 14336, v8
    v_add_u32 v11, 21504, v198
    s_lshl_b32 s45, s3, 12
    s_lshl_b32 s40, s36, 17
    s_lshl_b32 s57, s3, 15
    s_add_u32 s40, s40, s57
    s_mov_b32 m0, s45
    s_lshl_b32 s98, s36, 1
    s_add_u32 s98, s98, s2
    s_and_b32 s98, s98, 7
    s_lshl_b32 s59, s98, 7
    s_add_u32 s43, s59, s40
    s_mov_b32 s10, 0x200000
    s_mov_b32 s11, 0x20000
    s_waitcnt lgkmcnt(0)
    s_mov_b32 s8, s4
    s_mov_b32 s9, s5
    buffer_load_dwordx4 v8, s[8:11], s43 offen offset:0 lds
    s_and_b32 s37, s2, 6
    s_lshl_b32 s37, s37, 1
    s_lshr_b32 s38, s58, 3
    s_add_u32 s37, s37, s38
    v_and_b32 v195, 1, v193
    v_lshlrev_b32 v195, 2, v195
    buffer_load_dwordx4 v9, s[8:11], s43 offen offset:1024 lds
    v_xor_b32 v195, v195, v194
    v_lshlrev_b32 v195, 4, v195
    v_mul_u32_u24 v198, 3072, v192
    v_add_u32 v14, v198, v195
    v_add_u32 v12, 1024, v14
    v_xor_b32 v198, 32, v14
    buffer_load_dwordx4 v10, s[8:11], s43 offen offset:2048 lds
    v_add_u32 v13, 24576, v198
    v_add_u32 v15, 23552, v198
    s_and_b32 s41, s37, 7
    s_lshl_b32 s41, s41, 7
    s_mul_i32 s57, s3, 49152
    s_add_u32 s41, s41, s57
    buffer_load_dwordx4 v11, s[8:11], s43 offen offset:3072 lds
    s_add_u32 m0, s45, 16384
    s_mov_b32 s14, 0x180000
    s_mov_b32 s15, 0x20000
    s_mul_i32 s44, s98, 196608
    s_add_u32 s44, s44, s41
    s_cmp_ge_u32 s37, 8
    s_cselect_b32 s12, s64, s6
    s_cselect_b32 s13, s65, s7
    buffer_load_dwordx4 v12, s[12:15], s44 offen offset:0 lds
    v_lshlrev_b32 v16, 4, v1
    s_mov_b32 s24, s34
    s_mov_b32 s25, s35
    s_mov_b32 s34, 1024
    s_mov_b32 s35, 0x20000
    v_add_u32 v196, s59, v16
    v_and_b32 v196, 1023, v196
    v_and_b32 v198, 32, v1
    v_xor_b32 v195, v195, v198
    v_lshl_add_u32 v128, v192, 10, v195
    s_cmp_ge_u32 s3, 2
    s_cselect_b32 s16, s66, s16
    s_cselect_b32 s17, s67, s17
    s_mov_b32 s20, s30
    buffer_load_dwordx4 v13, s[12:15], s44 offen offset:1024 lds
    s_add_u32 s98, s98, 1
    s_and_b32 s98, s98, 7
    s_mov_b32 s21, s31
    s_mov_b32 s4, s30
    s_mov_b32 s5, s31
    s_mov_b32 s30, 256
    s_mov_b32 s31, 0x20000
    v_mov_b32 v39, 0
    s_and_b32 s66, s3, 1
    s_lshr_b32 s67, s3, 1
    s_lshl_b32 s58, s37, 1
    s_add_u32 s57, s66, s58
    s_lshl_b32 s55, s57, 11
    s_lshl_b32 s62, s57, 14
    buffer_load_dwordx4 v14, s[12:15], s44 offen offset:2048 lds
    s_add_u32 s62, s62, 4194304
    s_lshl_b32 s53, s36, 10
    s_add_u32 s53, s53, s62
    s_lshl_b32 s58, s67, 13
    s_add_u32 s62, s62, s58
    s_lshl_b32 s57, s57, 1
    s_add_u32 s57, s57, s67
    s_lshl_b32 s63, s57, 11
    s_add_u32 s63, s63, 4718592
    s_lshl_b32 s54, s36, 7
    s_add_u32 s54, s54, s63
    s_mov_b32 s22, 5046272
    buffer_load_dwordx4 v15, s[12:15], s44 offen offset:3072 lds
    s_mov_b32 s23, 0x20000
    s_sub_u32 s7, 0, s67
    s_not_b32 s6, s7
    v_mov_b32 v244, -1
    v_mov_b32 v245, -1
    v_mov_b32 v246, -1
    v_mov_b32 v247, -1
    s_or_b32 s57, s2, s3
    s_cmp_lg_u32 s57, 0
    s_cbranch_scc1 L_nn1
    s_or_b32 s68, s68, 1
    v_mov_b32 v4, s68
    v_mov_b32 v5, s69
    s_mov_b64 exec, 1
    buffer_store_dwordx2 v[4:5], v39, s[28:31], 0 offen sc1
    s_mov_b64 exec, -1
L_nn1:
    v_and_b32 v192, 15, v1
    s_lshl_b32 s57, s67, 13
    v_lshl_add_u32 v194, v192, 7, s57
    v_lshrrev_b32 v195, 1, v192
    s_mov_b32 m0, 162816
    v_xor_b32 v195, v195, v193
    v_lshl_add_u32 v18, v195, 4, v194
    buffer_load_dwordx4 v196, s[32:35], 0 offen lds
    v_xor_b32 v21, 64, v18
    v_add_u32 v19, 65536, v18
    v_add_u32 v20, 131072, v18
    v_add_u32 v22, 65536, v21
    v_add_u32 v23, 131072, v21
    v_bfe_u32 v195, v1, 2, 2
    v_lshlrev_b32 v194, 7, v195
    v_and_b32 v195, 3, v1
    v_lshl_add_u32 v194, v195, 3, v194
    v_lshrrev_b32 v195, 5, v1
    v_lshl_add_u32 v194, v195, 12, v194
    v_bfe_u32 v195, v1, 4, 1
    s_mov_b64 exec, s[6:7]
    buffer_store_dwordx4 v[244:247], v16, s[20:23], s53 offen sc1
    s_mov_b64 exec, 0xff
    buffer_store_dwordx4 v[244:247], v16, s[20:23], s54 offen sc1
    s_mov_b64 exec, -1
    s_add_u32 m0, s45, 32768
    s_lshl_b32 s43, s98, 7
    s_add_u32 s43, s43, s40
    buffer_load_dwordx4 v8, s[8:11], s43 offen offset:0 lds
    v_lshl_add_u32 v194, v195, 5, v194
    v_bfe_u32 v198, v1, 3, 1
    v_xor_b32 v30, s67, v198
    v_xor_b32 v198, s66, v198
    v_lshl_add_u32 v198, v198, 6, v194
    v_lshl_add_u32 v24, v195, 10, v198
    v_xor_b32 v27, 32, v24
    v_add_u32 v25, 65536, v24
    v_add_u32 v26, 131072, v24
    v_add_u32 v28, 65536, v27
    v_add_u32 v29, 131072, v27
    v_lshl_add_u32 v30, v30, 6, v194
    buffer_load_dwordx4 v9, s[8:11], s43 offen offset:1024 lds
    v_lshl_add_u32 v30, v195, 9, v30
    v_add_u32 v30, s57, v30
    v_lshlrev_b32 v138, 10, v192
    v_lshl_add_u32 v138, v195, 5, v138
    v_lshrrev_b32 v195, 5, v1
    v_lshl_add_u32 v138, v195, 4, v138
    s_lshl_b32 s57, s37, 3
    s_lshl_b32 s58, s3, 1
    s_add_u32 s57, s57, s58
    v_add_u32 v194, s57, v195
    v_lshlrev_b32 v3, 6, v195
    v_bfe_u32 v195, v194, 1, 3
    buffer_load_dwordx4 v10, s[8:11], s43 offen offset:2048 lds
    s_mul_i32 s44, s98, 196608
    s_add_u32 s44, s44, s41
    v_bfe_u32 v198, v1, 2, 3
    v_xor_b32 v195, v195, v198
    v_lshlrev_b32 v195, 4, v195
    v_lshl_add_u32 v195, v194, 7, v195
    v_and_b32 v198, 3, v1
    v_lshl_add_u32 v33, v198, 2, v195
    v_add_u32 v34, 65536, v33
    v_add_u32 v35, 131072, v33
    v_lshl_add_u32 v3, v198, 4, v3
    s_lshl_b32 s57, s66, 7
    s_lshl_b32 s58, s67, 6
    s_add_u32 s57, s57, s58
    buffer_load_dwordx4 v11, s[8:11], s43 offen offset:3072 lds
    s_add_u32 m0, s45, 49152
    s_add_u32 s57, s57, 8192
    v_lshl_add_u32 v143, v198, 4, s57
    v_and_b32 v199, 31, v1
    v_lshlrev_b32 v199, 2, v199
    v_add_u32 v199, 162816, v199
    v_mov_b32 v36, 0
    s_mov_b32 s18, 0x80000
    s_mov_b32 s19, 0x20000
    s_mov_b32 s26, 0x200000
    s_mov_b32 s27, 0x20000
    s_lshr_b32 s58, s2, 3
    s_and_b32 s57, s2, 7
    buffer_load_dwordx4 v12, s[12:15], s44 offen offset:0 lds
    s_lshl_b32 s38, s57, 2
    s_and_b32 s39, s58, 3
    s_add_u32 s38, s38, s39
    s_lshl_b32 s101, s39, 1
    s_lshr_b32 s39, s58, 2
    s_and_b32 s100, s2, 1
    s_add_u32 s101, s101, s100
    s_lshl_b32 s100, s101, 16
    s_lshl_b32 s101, s101, 12
    s_lshl_b32 s48, 0x55555555, s67
    s_mov_b32 s49, s48
    s_mov_b32 s50, 1069066811
    buffer_load_dwordx4 v13, s[12:15], s44 offen offset:1024 lds
    s_add_u32 s98, s98, 1
    s_and_b32 s98, s98, 7
    s_mov_b32 s51, 1069066811
    s_mov_b32 s52, 897988541
    s_mov_b32 s59, 0
    s_lshl_b32 s57, s36, 1
    s_add_u32 s57, s57, s67
    s_lshl_b32 s57, s57, 17
    s_add_u32 s55, s55, s57
    s_add_u32 s61, s55, 65536
    s_lshl_b32 s56, s36, 13
    s_lshl_b32 s57, s37, 9
    s_add_u32 s56, s56, s57
    s_lshl_b32 s57, s3, 7
    buffer_load_dwordx4 v14, s[12:15], s44 offen offset:2048 lds
    s_add_u32 s56, s56, s57
    s_add_u32 s56, s56, 4849664
    s_lshl_b32 s42, s36, 4
    s_add_u32 s42, s42, s37
    s_lshl_b32 s42, s42, 7
    s_add_u32 s42, s42, 4980736
    v_add_u32 v129, 15360, v128
    v_add_u32 v130, 30720, v128
    v_add_u32 v131, 46080, v128
    v_and_b32 v194, 48, v1
    v_lshl_add_u32 v2, v192, 7, v194
    s_lshl_b32 s57, s3, 7
    buffer_load_dwordx4 v15, s[12:15], s44 offen offset:3072 lds
    s_add_u32 s57, s57, 8192
    v_add_u32 v142, s57, v194
    s_lshl_b32 s57, s37, 7
    s_add_u32 s57, s57, 5013504
    v_lshl_add_u32 v17, v192, 11, s57
    s_lshr_b32 s57, s38, 1
    s_lshl_b32 s57, s57, 11
    s_add_u32 s57, s57, 4980736
    v_lshl_add_u32 v0, v192, 7, s57
    v_mov_b32 v240, 0x3f803f80
    v_mov_b32 v241, 0x3f803f80
    v_mov_b32 v242, 0x3f803f80
    v_mov_b32 v243, 0x3f803f80
    s_lshl_b32 s60, s39, 7
    s_lshl_b32 s57, s66, 13
    s_add_u32 s60, s60, s57
    s_lshl_b32 s64, s38, 1
    s_add_u32 s64, s64, s66
    s_lshl_b32 s65, s64, 11
    s_add_u32 s65, s65, 4849712
    s_lshl_b32 s47, s64, 15
    s_lshl_b32 s64, s64, 16
    s_lshl_b32 s58, s67, 15
    s_add_u32 s64, s64, s58
    s_lshl_b32 s57, s39, 7
    s_add_u32 s47, s47, s57
    s_lshl_b32 s57, s67, 6
    s_add_u32 s47, s47, s57
    v_add_u32 v139, s45, v16
    s_lshl_b32 s57, s3, 11
    v_add_u32 v140, s57, v16
    v_xor_b32 v141, 4096, v140
    s_lshl_b32 s57, s3, 9
    s_add_u32 s57, s57, 12288
    v_lshl_add_u32 v31, v1, 3, s57
    s_lshl_b32 s57, s66, 9
    s_add_u32 s57, s57, 12288
    v_lshl_add_u32 v32, v1, 3, s57
    v_and_b32 v194, 1, v1
    v_lshlrev_b32 v194, 4, v194
    v_mov_b32 v195, 0x3f80
    v_lshlrev_b32 v194, v194, v195
    v_lshrrev_b32 v195, 2, v192
    v_xor_b32 v195, v195, v193
    v_lshlrev_b32 v195, 1, v195
    v_bfe_u32 v198, v1, 1, 1
    v_or_b32 v195, v195, v198
    v_mov_b32 v132, 0
    v_mov_b32 v133, 0
    v_cmp_eq_u32 vcc, 0, v195
    v_mov_b32 v136, 0
    v_mov_b32 v137, 0
    v_cndmask_b32 v134, 0, v194, vcc
    v_cmp_eq_u32 vcc, 1, v195
    s_nop 1
    v_cndmask_b32 v135, 0, v194, vcc
    s_waitcnt vmcnt(10)
    s_barrier
    ds_read_b128 a[0:3], v18 offset:0
    ds_read_b64_tr_b16 v[112:113], v24 offset:16384
    ds_read_b64_tr_b16 v[114:115], v24 offset:16896
    ds_read_b64_tr_b16 v[116:117], v27 offset:16384
    ds_read_b64_tr_b16 v[118:119], v27 offset:16896
    ds_read_b64_tr_b16 v[120:121], v24 offset:18432
    ds_read_b64_tr_b16 v[122:123], v24 offset:18944
    ds_read_b64_tr_b16 v[124:125], v27 offset:18432
    ds_read_b64_tr_b16 v[126:127], v27 offset:18944
    ds_read_b128 a[4:7], v18 offset:2048
    ds_read_b128 a[8:11], v18 offset:4096
    ds_read_b128 a[12:15], v18 offset:6144
    ds_read_b32 v37, v33 offset:0
    s_waitcnt lgkmcnt(6)
    v_mfma_f32_16x16x32_bf16 v[48:51], a[0:3], v[112:115], 0
    v_mfma_f32_16x16x32_bf16 v[64:67], a[0:3], v[116:119], 0
    s_add_u32 m0, s45, 65536
    s_lshl_b32 s43, s98, 7
    s_add_u32 s43, s43, s40
    buffer_load_dwordx4 v8, s[8:11], s43 offen offset:0 lds
    v_mfma_f32_16x16x32_bf16 v[80:83], a[0:3], v[120:123], 0
    s_waitcnt lgkmcnt(0)
    v_mfma_f32_16x16x32_bf16 v[96:99], a[0:3], v[124:127], 0
    buffer_load_dwordx4 v9, s[8:11], s43 offen offset:1024 lds
    v_mfma_f32_16x16x32_bf16 v[100:103], a[4:7], v[124:127], 0
    v_mfma_f32_16x16x32_bf16 v[84:87], a[4:7], v[120:123], 0
    v_mfma_f32_16x16x32_bf16 v[68:71], a[4:7], v[116:119], 0
    ds_read_b128 a[16:19], v21 offset:0
    ds_read_b64_tr_b16 v[144:145], v24 offset:24576
    v_mfma_f32_16x16x32_bf16 v[52:55], a[4:7], v[112:115], 0
    buffer_load_dwordx4 v10, s[8:11], s43 offen offset:2048 lds
    s_mul_i32 s44, s98, 196608
    s_add_u32 s44, s44, s41
    v_mfma_f32_16x16x32_bf16 v[56:59], a[8:11], v[112:115], 0
    ds_read_b64_tr_b16 v[146:147], v24 offset:25088
    ds_read_b64_tr_b16 v[148:149], v27 offset:24576
    v_mfma_f32_16x16x32_bf16 v[72:75], a[8:11], v[116:119], 0
    buffer_load_dwordx4 v11, s[8:11], s43 offen offset:3072 lds
    s_add_u32 m0, s45, 81920
    v_mfma_f32_16x16x32_bf16 v[88:91], a[8:11], v[120:123], 0
    ds_read_b64_tr_b16 v[150:151], v27 offset:25088
    ds_read_b64_tr_b16 v[152:153], v24 offset:26624
    v_mfma_f32_16x16x32_bf16 v[104:107], a[8:11], v[124:127], 0
    buffer_load_dwordx4 v12, s[12:15], s44 offen offset:0 lds
    ds_read_b64_tr_b16 v[154:155], v24 offset:27136
    v_mfma_f32_16x16x32_bf16 v[108:111], a[12:15], v[124:127], 0
    ds_read_b64_tr_b16 v[156:157], v27 offset:26624
    ds_read_b64_tr_b16 v[158:159], v27 offset:27136
    v_mfma_f32_16x16x32_bf16 v[92:95], a[12:15], v[120:123], 0
    ds_read_b128 a[20:23], v21 offset:2048
    ds_read_b128 a[24:27], v21 offset:4096
    v_mfma_f32_16x16x32_bf16 v[76:79], a[12:15], v[116:119], 0
    ds_read_b128 a[28:31], v21 offset:6144
    ds_read2_b32 v[40:41], v199 offset0:0 offset1:32
    v_mfma_f32_16x16x32_bf16 v[60:63], a[12:15], v[112:115], 0
    buffer_load_dwordx4 v13, s[12:15], s44 offen offset:1024 lds
    s_add_u32 s98, s98, 1
    s_and_b32 s98, s98, 7
    ds_read2_b32 v[42:43], v199 offset0:64 offset1:96
    ds_read2_b32 v[44:45], v199 offset0:128 offset1:160
    ds_read2_b32 v[46:47], v199 offset0:192 offset1:224
    s_waitcnt lgkmcnt(9)
    v_mfma_f32_16x16x32_bf16 v[48:51], a[16:19], v[144:147], v[48:51]
    v_mfma_f32_16x16x32_bf16 v[64:67], a[16:19], v[148:151], v[64:67]
    buffer_load_dwordx4 v14, s[12:15], s44 offen offset:2048 lds
    v_mfma_f32_16x16x32_bf16 v[80:83], a[16:19], v[152:155], v[80:83]
    s_waitcnt lgkmcnt(3)
    v_mfma_f32_16x16x32_bf16 v[96:99], a[16:19], v[156:159], v[96:99]
    buffer_load_dwordx4 v15, s[12:15], s44 offen offset:3072 lds
    v_mfma_f32_16x16x32_bf16 v[100:103], a[20:23], v[156:159], v[100:103]
    v_mfma_f32_16x16x32_bf16 v[84:87], a[20:23], v[152:155], v[84:87]
    s_waitcnt vmcnt(8) lgkmcnt(0)
    s_barrier
    v_mfma_f32_16x16x32_bf16 v[68:71], a[20:23], v[148:151], v[68:71]
    ds_read_b128 a[32:35], v18 offset:32768
    ds_read_b64_tr_b16 v[112:113], v24 offset:49152
    v_mfma_f32_16x16x32_bf16 v[52:55], a[20:23], v[144:147], v[52:55]
    s_add_u32 m0, s45, 98304
    s_lshl_b32 s43, s98, 7
    s_add_u32 s43, s43, s40
    buffer_load_dwordx4 v8, s[8:11], s43 offen offset:0 lds
    v_mfma_f32_16x16x32_bf16 v[56:59], a[24:27], v[144:147], v[56:59]
    ds_read_b64_tr_b16 v[114:115], v24 offset:49664
    ds_read_b64_tr_b16 v[116:117], v27 offset:49152
    v_mfma_f32_16x16x32_bf16 v[72:75], a[24:27], v[148:151], v[72:75]
    buffer_load_dwordx4 v9, s[8:11], s43 offen offset:1024 lds
    v_mfma_f32_16x16x32_bf16 v[88:91], a[24:27], v[152:155], v[88:91]
    ds_read_b64_tr_b16 v[118:119], v27 offset:49664
    ds_read_b64_tr_b16 v[120:121], v24 offset:51200
    v_mfma_f32_16x16x32_bf16 v[104:107], a[24:27], v[156:159], v[104:107]
    buffer_load_dwordx4 v10, s[8:11], s43 offen offset:2048 lds
    s_mul_i32 s44, s98, 196608
    s_add_u32 s44, s44, s41
    v_mfma_f32_16x16x32_bf16 v[108:111], a[28:31], v[156:159], v[108:111]
    ds_read_b64_tr_b16 v[122:123], v24 offset:51712
    ds_read_b64_tr_b16 v[124:125], v27 offset:51200
    v_mfma_f32_16x16x32_bf16 v[92:95], a[28:31], v[152:155], v[92:95]
    ds_read_b64_tr_b16 v[126:127], v27 offset:51712
    ds_read_b128 a[36:39], v18 offset:34816
    v_mfma_f32_16x16x32_bf16 v[76:79], a[28:31], v[148:151], v[76:79]
    ds_read_b128 a[40:43], v18 offset:36864
    ds_read_b128 a[44:47], v18 offset:38912
    v_mfma_f32_16x16x32_bf16 v[60:63], a[28:31], v[144:147], v[60:63]
    buffer_load_dwordx4 v11, s[8:11], s43 offen offset:3072 lds
    s_add_u32 m0, s45, 114688
    ds_read_b32 v38, v33 offset:32768
    v_dot2c_f32_bf16 v36, v37, v40
    s_waitcnt lgkmcnt(6)
    v_mfma_f32_16x16x32_bf16 v[48:51], a[32:35], v[112:115], v[48:51]
    v_mfma_f32_16x16x32_bf16 v[64:67], a[32:35], v[116:119], v[64:67]
    buffer_load_dwordx4 v12, s[12:15], s44 offen offset:0 lds
    v_mfma_f32_16x16x32_bf16 v[80:83], a[32:35], v[120:123], v[80:83]
    s_waitcnt lgkmcnt(0)
    v_mfma_f32_16x16x32_bf16 v[96:99], a[32:35], v[124:127], v[96:99]
    buffer_load_dwordx4 v13, s[12:15], s44 offen offset:1024 lds
    s_add_u32 s98, s98, 1
    s_and_b32 s98, s98, 7
    v_mfma_f32_16x16x32_bf16 v[100:103], a[36:39], v[124:127], v[100:103]
    v_mfma_f32_16x16x32_bf16 v[84:87], a[36:39], v[120:123], v[84:87]
    v_mfma_f32_16x16x32_bf16 v[68:71], a[36:39], v[116:119], v[68:71]
    ds_read_b128 a[48:51], v21 offset:32768
    ds_read_b64_tr_b16 v[144:145], v24 offset:57344
    v_mfma_f32_16x16x32_bf16 v[52:55], a[36:39], v[112:115], v[52:55]
    buffer_load_dwordx4 v14, s[12:15], s44 offen offset:2048 lds
    v_mfma_f32_16x16x32_bf16 v[56:59], a[40:43], v[112:115], v[56:59]
    ds_read_b64_tr_b16 v[146:147], v24 offset:57856
    ds_read_b64_tr_b16 v[148:149], v27 offset:57344
    v_mfma_f32_16x16x32_bf16 v[72:75], a[40:43], v[116:119], v[72:75]
    buffer_load_dwordx4 v15, s[12:15], s44 offen offset:3072 lds
    v_mfma_f32_16x16x32_bf16 v[88:91], a[40:43], v[120:123], v[88:91]
    ds_read_b64_tr_b16 v[150:151], v27 offset:57856
    ds_read_b64_tr_b16 v[152:153], v24 offset:59392
    v_mfma_f32_16x16x32_bf16 v[104:107], a[40:43], v[124:127], v[104:107]
    s_add_u32 m0, s45, 131072
    s_lshl_b32 s43, s98, 7
    s_add_u32 s43, s43, s40
    buffer_load_dwordx4 v8, s[8:11], s43 offen offset:0 lds
    v_mfma_f32_16x16x32_bf16 v[108:111], a[44:47], v[124:127], v[108:111]
    ds_read_b64_tr_b16 v[154:155], v24 offset:59904
    ds_read_b64_tr_b16 v[156:157], v27 offset:59392
    v_mfma_f32_16x16x32_bf16 v[92:95], a[44:47], v[120:123], v[92:95]
    ds_read_b64_tr_b16 v[158:159], v27 offset:59904
    ds_read_b128 a[52:55], v21 offset:34816
    v_mfma_f32_16x16x32_bf16 v[76:79], a[44:47], v[116:119], v[76:79]
    ds_read_b128 a[56:59], v21 offset:36864
    ds_read_b128 a[60:63], v21 offset:38912
    v_mfma_f32_16x16x32_bf16 v[60:63], a[44:47], v[112:115], v[60:63]
    buffer_load_dwordx4 v9, s[8:11], s43 offen offset:1024 lds
    s_waitcnt lgkmcnt(5)
    v_mfma_f32_16x16x32_bf16 v[48:51], a[48:51], v[144:147], v[48:51]
    v_mfma_f32_16x16x32_bf16 v[64:67], a[48:51], v[148:151], v[64:67]
    buffer_load_dwordx4 v10, s[8:11], s43 offen offset:2048 lds
    s_mul_i32 s44, s98, 196608
    s_add_u32 s44, s44, s41
    v_mfma_f32_16x16x32_bf16 v[80:83], a[48:51], v[152:155], v[80:83]
    s_waitcnt lgkmcnt(0)
    v_mfma_f32_16x16x32_bf16 v[96:99], a[48:51], v[156:159], v[96:99]
    buffer_load_dwordx4 v11, s[8:11], s43 offen offset:3072 lds
    s_add_u32 m0, s45, 147456
    v_mfma_f32_16x16x32_bf16 v[100:103], a[52:55], v[156:159], v[100:103]
    v_mfma_f32_16x16x32_bf16 v[84:87], a[52:55], v[152:155], v[84:87]
    s_waitcnt vmcnt(12)
    s_barrier
    v_mfma_f32_16x16x32_bf16 v[68:71], a[52:55], v[148:151], v[68:71]
    ds_read_b128 a[64:67], v19 offset:0
    ds_read_b64_tr_b16 v[112:113], v25 offset:16384
    v_mfma_f32_16x16x32_bf16 v[52:55], a[52:55], v[144:147], v[52:55]
    buffer_load_dwordx4 v12, s[12:15], s44 offen offset:0 lds
    v_mfma_f32_16x16x32_bf16 v[56:59], a[56:59], v[144:147], v[56:59]
    ds_read_b64_tr_b16 v[114:115], v25 offset:16896
    ds_read_b64_tr_b16 v[116:117], v28 offset:16384
    v_mfma_f32_16x16x32_bf16 v[72:75], a[56:59], v[148:151], v[72:75]
    buffer_load_dwordx4 v13, s[12:15], s44 offen offset:1024 lds
    s_add_u32 s98, s98, 1
    s_and_b32 s98, s98, 7
    v_mfma_f32_16x16x32_bf16 v[88:91], a[56:59], v[152:155], v[88:91]
    ds_read_b64_tr_b16 v[118:119], v28 offset:16896
    ds_read_b64_tr_b16 v[120:121], v25 offset:18432
    v_mfma_f32_16x16x32_bf16 v[104:107], a[56:59], v[156:159], v[104:107]
    buffer_load_dwordx4 v14, s[12:15], s44 offen offset:2048 lds
    v_mfma_f32_16x16x32_bf16 v[108:111], a[60:63], v[156:159], v[108:111]
    ds_read_b64_tr_b16 v[122:123], v25 offset:18944
    ds_read_b64_tr_b16 v[124:125], v28 offset:18432
    v_mfma_f32_16x16x32_bf16 v[92:95], a[60:63], v[152:155], v[92:95]
    ds_read_b64_tr_b16 v[126:127], v28 offset:18944
    ds_read_b128 a[68:71], v19 offset:2048
    v_mfma_f32_16x16x32_bf16 v[76:79], a[60:63], v[148:151], v[76:79]
    ds_read_b128 a[72:75], v19 offset:4096
    ds_read_b128 a[76:79], v19 offset:6144
    buffer_load_dwordx4 v[4:7], v39, s[28:31], 0 offen sc1
    v_mfma_f32_16x16x32_bf16 v[60:63], a[60:63], v[144:147], v[60:63]
    buffer_load_dwordx4 v15, s[12:15], s44 offen offset:3072 lds
    ds_read_b32 v37, v34 offset:0
    v_dot2c_f32_bf16 v36, v38, v41
    s_waitcnt lgkmcnt(6)
    v_mfma_f32_16x16x32_bf16 v[48:51], a[64:67], v[112:115], v[48:51]
    v_mfma_f32_16x16x32_bf16 v[64:67], a[64:67], v[116:119], v[64:67]
    s_add_u32 m0, s45, 0
    s_lshl_b32 s43, s98, 7
    s_add_u32 s43, s43, s40
    buffer_load_dwordx4 v8, s[8:11], s43 offen offset:0 lds
    v_mfma_f32_16x16x32_bf16 v[80:83], a[64:67], v[120:123], v[80:83]
    s_waitcnt lgkmcnt(0)
    v_mfma_f32_16x16x32_bf16 v[96:99], a[64:67], v[124:127], v[96:99]
    buffer_load_dwordx4 v9, s[8:11], s43 offen offset:1024 lds
    v_mfma_f32_16x16x32_bf16 v[100:103], a[68:71], v[124:127], v[100:103]
    v_mfma_f32_16x16x32_bf16 v[84:87], a[68:71], v[120:123], v[84:87]
    v_mfma_f32_16x16x32_bf16 v[68:71], a[68:71], v[116:119], v[68:71]
    ds_read_b128 a[80:83], v22 offset:0
    ds_read_b64_tr_b16 v[144:145], v25 offset:24576
    v_mfma_f32_16x16x32_bf16 v[52:55], a[68:71], v[112:115], v[52:55]
    buffer_load_dwordx4 v10, s[8:11], s43 offen offset:2048 lds
    s_mul_i32 s44, s98, 196608
    s_add_u32 s44, s44, s41
    v_mfma_f32_16x16x32_bf16 v[56:59], a[72:75], v[112:115], v[56:59]
    ds_read_b64_tr_b16 v[146:147], v25 offset:25088
    ds_read_b64_tr_b16 v[148:149], v28 offset:24576
    v_mfma_f32_16x16x32_bf16 v[72:75], a[72:75], v[116:119], v[72:75]
    buffer_load_dwordx4 v11, s[8:11], s43 offen offset:3072 lds
    s_add_u32 m0, s45, 16384
    v_mfma_f32_16x16x32_bf16 v[88:91], a[72:75], v[120:123], v[88:91]
    ds_read_b64_tr_b16 v[150:151], v28 offset:25088
    ds_read_b64_tr_b16 v[152:153], v25 offset:26624
    v_mfma_f32_16x16x32_bf16 v[104:107], a[72:75], v[124:127], v[104:107]
    buffer_load_dwordx4 v12, s[12:15], s44 offen offset:0 lds
    v_mfma_f32_16x16x32_bf16 v[108:111], a[76:79], v[124:127], v[108:111]
    ds_read_b64_tr_b16 v[154:155], v25 offset:27136
    ds_read_b64_tr_b16 v[156:157], v28 offset:26624
    v_mfma_f32_16x16x32_bf16 v[92:95], a[76:79], v[120:123], v[92:95]
    ds_read_b64_tr_b16 v[158:159], v28 offset:27136
    ds_read_b128 a[84:87], v22 offset:2048
    v_mfma_f32_16x16x32_bf16 v[76:79], a[76:79], v[116:119], v[76:79]
    ds_read_b128 a[88:91], v22 offset:4096
    ds_read_b128 a[92:95], v22 offset:6144
    v_mfma_f32_16x16x32_bf16 v[60:63], a[76:79], v[112:115], v[60:63]
    buffer_load_dwordx4 v13, s[12:15], s44 offen offset:1024 lds
    s_add_u32 s98, s98, 1
    s_and_b32 s98, s98, 7
    s_waitcnt lgkmcnt(5)
    v_mfma_f32_16x16x32_bf16 v[48:51], a[80:83], v[144:147], v[48:51]
    v_mfma_f32_16x16x32_bf16 v[64:67], a[80:83], v[148:151], v[64:67]
    v_mfma_f32_16x16x32_bf16 v[80:83], a[80:83], v[152:155], v[80:83]
    s_waitcnt lgkmcnt(0)
    v_mfma_f32_16x16x32_bf16 v[96:99], a[80:83], v[156:159], v[96:99]
    buffer_load_dwordx4 v14, s[12:15], s44 offen offset:2048 lds
    v_mfma_f32_16x16x32_bf16 v[100:103], a[84:87], v[156:159], v[100:103]
    v_mfma_f32_16x16x32_bf16 v[84:87], a[84:87], v[152:155], v[84:87]
    s_waitcnt vmcnt(16)
    s_barrier
    v_mfma_f32_16x16x32_bf16 v[68:71], a[84:87], v[148:151], v[68:71]
    ds_read_b128 a[96:99], v19 offset:32768
    ds_read_b64_tr_b16 v[112:113], v25 offset:49152
    v_mfma_f32_16x16x32_bf16 v[52:55], a[84:87], v[144:147], v[52:55]
    buffer_load_dwordx4 v15, s[12:15], s44 offen offset:3072 lds
    v_mfma_f32_16x16x32_bf16 v[56:59], a[88:91], v[144:147], v[56:59]
    ds_read_b64_tr_b16 v[114:115], v25 offset:49664
    ds_read_b64_tr_b16 v[116:117], v28 offset:49152
    v_mfma_f32_16x16x32_bf16 v[72:75], a[88:91], v[148:151], v[72:75]
    ds_read_b64_tr_b16 v[118:119], v28 offset:49664
    ds_read_b64_tr_b16 v[120:121], v25 offset:51200
    v_mfma_f32_16x16x32_bf16 v[88:91], a[88:91], v[152:155], v[88:91]
    ds_read_b64_tr_b16 v[122:123], v25 offset:51712
    ds_read_b64_tr_b16 v[124:125], v28 offset:51200
    v_mfma_f32_16x16x32_bf16 v[104:107], a[88:91], v[156:159], v[104:107]
    s_add_u32 m0, s45, 32768
    s_lshl_b32 s43, s98, 7
    s_add_u32 s43, s43, s40
    buffer_load_dwordx4 v8, s[8:11], s43 offen offset:0 lds
    v_mfma_f32_16x16x32_bf16 v[108:111], a[92:95], v[156:159], v[108:111]
    ds_read_b64_tr_b16 v[126:127], v28 offset:51712
    ds_read_b128 a[100:103], v19 offset:34816
    v_mfma_f32_16x16x32_bf16 v[92:95], a[92:95], v[152:155], v[92:95]
    ds_read_b128 a[104:107], v19 offset:36864
    ds_read_b128 a[108:111], v19 offset:38912
    v_mfma_f32_16x16x32_bf16 v[76:79], a[92:95], v[148:151], v[76:79]
    ds_read_b32 v38, v34 offset:32768
    v_mfma_f32_16x16x32_bf16 v[60:63], a[92:95], v[144:147], v[60:63]
    buffer_load_dwordx4 v9, s[8:11], s43 offen offset:1024 lds
    v_dot2c_f32_bf16 v36, v37, v42
    s_waitcnt lgkmcnt(6)
    v_mfma_f32_16x16x32_bf16 v[48:51], a[96:99], v[112:115], v[48:51]
    v_mfma_f32_16x16x32_bf16 v[64:67], a[96:99], v[116:119], v[64:67]
    v_mfma_f32_16x16x32_bf16 v[80:83], a[96:99], v[120:123], v[80:83]
    s_waitcnt lgkmcnt(0)
    v_mfma_f32_16x16x32_bf16 v[96:99], a[96:99], v[124:127], v[96:99]
    buffer_load_dwordx4 v10, s[8:11], s43 offen offset:2048 lds
    s_mul_i32 s44, s98, 196608
    s_add_u32 s44, s44, s41
    v_mfma_f32_16x16x32_bf16 v[100:103], a[100:103], v[124:127], v[100:103]
    v_mfma_f32_16x16x32_bf16 v[84:87], a[100:103], v[120:123], v[84:87]
    v_mfma_f32_16x16x32_bf16 v[68:71], a[100:103], v[116:119], v[68:71]
    ds_read_b128 a[112:115], v22 offset:32768
    ds_read_b64_tr_b16 v[144:145], v25 offset:57344
    v_mfma_f32_16x16x32_bf16 v[52:55], a[100:103], v[112:115], v[52:55]
    buffer_load_dwordx4 v11, s[8:11], s43 offen offset:3072 lds
    s_add_u32 m0, s45, 49152
    v_mfma_f32_16x16x32_bf16 v[56:59], a[104:107], v[112:115], v[56:59]
    ds_read_b64_tr_b16 v[146:147], v25 offset:57856
    ds_read_b64_tr_b16 v[148:149], v28 offset:57344
    v_mfma_f32_16x16x32_bf16 v[72:75], a[104:107], v[116:119], v[72:75]
    ds_read_b64_tr_b16 v[150:151], v28 offset:57856
    ds_read_b64_tr_b16 v[152:153], v25 offset:59392
    v_mfma_f32_16x16x32_bf16 v[88:91], a[104:107], v[120:123], v[88:91]
    ds_read_b64_tr_b16 v[154:155], v25 offset:59904
    ds_read_b64_tr_b16 v[156:157], v28 offset:59392
    v_mfma_f32_16x16x32_bf16 v[104:107], a[104:107], v[124:127], v[104:107]
    buffer_load_dwordx4 v12, s[12:15], s44 offen offset:0 lds
    v_mfma_f32_16x16x32_bf16 v[108:111], a[108:111], v[124:127], v[108:111]
    ds_read_b64_tr_b16 v[158:159], v28 offset:59904
    ds_read_b128 a[116:119], v22 offset:34816
    v_mfma_f32_16x16x32_bf16 v[92:95], a[108:111], v[120:123], v[92:95]
    ds_read_b128 a[120:123], v22 offset:36864
    ds_read_b128 a[124:127], v22 offset:38912
    v_mfma_f32_16x16x32_bf16 v[76:79], a[108:111], v[116:119], v[76:79]
    v_mfma_f32_16x16x32_bf16 v[60:63], a[108:111], v[112:115], v[60:63]
    buffer_load_dwordx4 v13, s[12:15], s44 offen offset:1024 lds
    s_add_u32 s98, s98, 1
    s_and_b32 s98, s98, 7
    s_waitcnt lgkmcnt(5)
    v_mfma_f32_16x16x32_bf16 v[48:51], a[112:115], v[144:147], v[48:51]
    v_mfma_f32_16x16x32_bf16 v[64:67], a[112:115], v[148:151], v[64:67]
    v_mfma_f32_16x16x32_bf16 v[80:83], a[112:115], v[152:155], v[80:83]
    s_waitcnt lgkmcnt(0)
    v_mfma_f32_16x16x32_bf16 v[96:99], a[112:115], v[156:159], v[96:99]
    buffer_load_dwordx4 v14, s[12:15], s44 offen offset:2048 lds
    v_mfma_f32_16x16x32_bf16 v[100:103], a[116:119], v[156:159], v[100:103]
    v_mfma_f32_16x16x32_bf16 v[84:87], a[116:119], v[152:155], v[84:87]
    s_waitcnt vmcnt(15)
    s_barrier
    v_mfma_f32_16x16x32_bf16 v[68:71], a[116:119], v[148:151], v[68:71]
    ds_read_b128 a[128:131], v20 offset:0
    ds_read_b64_tr_b16 v[112:113], v26 offset:16384
    v_mfma_f32_16x16x32_bf16 v[52:55], a[116:119], v[144:147], v[52:55]
    buffer_load_dwordx4 v15, s[12:15], s44 offen offset:3072 lds
    v_mfma_f32_16x16x32_bf16 v[56:59], a[120:123], v[144:147], v[56:59]
    ds_read_b64_tr_b16 v[114:115], v26 offset:16896
    ds_read_b64_tr_b16 v[116:117], v29 offset:16384
    v_mfma_f32_16x16x32_bf16 v[72:75], a[120:123], v[148:151], v[72:75]
    ds_read_b64_tr_b16 v[118:119], v29 offset:16896
    ds_read_b64_tr_b16 v[120:121], v26 offset:18432
    v_mfma_f32_16x16x32_bf16 v[88:91], a[120:123], v[152:155], v[88:91]
    ds_read_b64_tr_b16 v[122:123], v26 offset:18944
    ds_read_b64_tr_b16 v[124:125], v29 offset:18432
    v_mfma_f32_16x16x32_bf16 v[104:107], a[120:123], v[156:159], v[104:107]
    s_add_u32 m0, s45, 65536
    s_lshl_b32 s43, s98, 7
    s_add_u32 s43, s43, s40
    buffer_load_dwordx4 v8, s[8:11], s43 offen offset:0 lds
    v_mfma_f32_16x16x32_bf16 v[108:111], a[124:127], v[156:159], v[108:111]
    ds_read_b64_tr_b16 v[126:127], v29 offset:18944
    ds_read_b128 a[132:135], v20 offset:2048
    v_mfma_f32_16x16x32_bf16 v[92:95], a[124:127], v[152:155], v[92:95]
    ds_read_b128 a[136:139], v20 offset:4096
    ds_read_b128 a[140:143], v20 offset:6144
    v_mfma_f32_16x16x32_bf16 v[76:79], a[124:127], v[148:151], v[76:79]
    ds_read_b32 v37, v35 offset:0
    v_mfma_f32_16x16x32_bf16 v[60:63], a[124:127], v[144:147], v[60:63]
    buffer_load_dwordx4 v9, s[8:11], s43 offen offset:1024 lds
    v_dot2c_f32_bf16 v36, v38, v43
    s_waitcnt lgkmcnt(6)
    v_mfma_f32_16x16x32_bf16 v[48:51], a[128:131], v[112:115], v[48:51]
    v_mfma_f32_16x16x32_bf16 v[64:67], a[128:131], v[116:119], v[64:67]
    v_mfma_f32_16x16x32_bf16 v[80:83], a[128:131], v[120:123], v[80:83]
    s_waitcnt lgkmcnt(0)
    v_mfma_f32_16x16x32_bf16 v[96:99], a[128:131], v[124:127], v[96:99]
    buffer_load_dwordx4 v10, s[8:11], s43 offen offset:2048 lds
    s_mul_i32 s44, s98, 196608
    s_add_u32 s44, s44, s41
    v_mfma_f32_16x16x32_bf16 v[100:103], a[132:135], v[124:127], v[100:103]
    v_mfma_f32_16x16x32_bf16 v[84:87], a[132:135], v[120:123], v[84:87]
    v_mfma_f32_16x16x32_bf16 v[68:71], a[132:135], v[116:119], v[68:71]
    ds_read_b128 a[144:147], v23 offset:0
    ds_read_b64_tr_b16 v[144:145], v26 offset:24576
    v_mfma_f32_16x16x32_bf16 v[52:55], a[132:135], v[112:115], v[52:55]
    buffer_load_dwordx4 v11, s[8:11], s43 offen offset:3072 lds
    s_add_u32 m0, s45, 81920
    v_mfma_f32_16x16x32_bf16 v[56:59], a[136:139], v[112:115], v[56:59]
    ds_read_b64_tr_b16 v[146:147], v26 offset:25088
    ds_read_b64_tr_b16 v[148:149], v29 offset:24576
    v_mfma_f32_16x16x32_bf16 v[72:75], a[136:139], v[116:119], v[72:75]
    ds_read_b64_tr_b16 v[150:151], v29 offset:25088
    ds_read_b64_tr_b16 v[152:153], v26 offset:26624
    v_mfma_f32_16x16x32_bf16 v[88:91], a[136:139], v[120:123], v[88:91]
    ds_read_b64_tr_b16 v[154:155], v26 offset:27136
    ds_read_b64_tr_b16 v[156:157], v29 offset:26624
    v_mfma_f32_16x16x32_bf16 v[104:107], a[136:139], v[124:127], v[104:107]
    buffer_load_dwordx4 v12, s[12:15], s44 offen offset:0 lds
    v_mfma_f32_16x16x32_bf16 v[108:111], a[140:143], v[124:127], v[108:111]
    ds_read_b64_tr_b16 v[158:159], v29 offset:27136
    ds_read_b128 a[148:151], v23 offset:2048
    v_mfma_f32_16x16x32_bf16 v[92:95], a[140:143], v[120:123], v[92:95]
    ds_read_b128 a[152:155], v23 offset:4096
    ds_read_b128 a[156:159], v23 offset:6144
    v_mfma_f32_16x16x32_bf16 v[76:79], a[140:143], v[116:119], v[76:79]
    v_mfma_f32_16x16x32_bf16 v[60:63], a[140:143], v[112:115], v[60:63]
    buffer_load_dwordx4 v13, s[12:15], s44 offen offset:1024 lds
    s_add_u32 s98, s98, 1
    s_and_b32 s98, s98, 7
    s_waitcnt lgkmcnt(5)
    v_mfma_f32_16x16x32_bf16 v[48:51], a[144:147], v[144:147], v[48:51]
    v_mfma_f32_16x16x32_bf16 v[64:67], a[144:147], v[148:151], v[64:67]
    v_mfma_f32_16x16x32_bf16 v[80:83], a[144:147], v[152:155], v[80:83]
    s_waitcnt lgkmcnt(0)
    v_mfma_f32_16x16x32_bf16 v[96:99], a[144:147], v[156:159], v[96:99]
    buffer_load_dwordx4 v14, s[12:15], s44 offen offset:2048 lds
    v_mfma_f32_16x16x32_bf16 v[100:103], a[148:151], v[156:159], v[100:103]
    v_mfma_f32_16x16x32_bf16 v[84:87], a[148:151], v[152:155], v[84:87]
    s_waitcnt vmcnt(15)
    s_barrier
    v_mfma_f32_16x16x32_bf16 v[68:71], a[148:151], v[148:151], v[68:71]
    ds_read_b128 a[160:163], v18 offset:0
    ds_read_b64_tr_b16 v[112:113], v24 offset:16384
    v_mfma_f32_16x16x32_bf16 v[52:55], a[148:151], v[144:147], v[52:55]
    buffer_load_dwordx4 v15, s[12:15], s44 offen offset:3072 lds
    v_mfma_f32_16x16x32_bf16 v[56:59], a[152:155], v[144:147], v[56:59]
    ds_read_b64_tr_b16 v[114:115], v24 offset:16896
    ds_read_b64_tr_b16 v[116:117], v27 offset:16384
    v_mfma_f32_16x16x32_bf16 v[72:75], a[152:155], v[148:151], v[72:75]
    ds_read_b64_tr_b16 v[118:119], v27 offset:16896
    ds_read_b64_tr_b16 v[120:121], v24 offset:18432
    v_mfma_f32_16x16x32_bf16 v[88:91], a[152:155], v[152:155], v[88:91]
    ds_read_b64_tr_b16 v[122:123], v24 offset:18944
    ds_read_b64_tr_b16 v[124:125], v27 offset:18432
    v_mfma_f32_16x16x32_bf16 v[104:107], a[152:155], v[156:159], v[104:107]
    s_add_u32 m0, s45, 98304
    s_mul_i32 s44, s98, 196608
    s_add_u32 s44, s44, s41
    buffer_load_dwordx4 v14, s[12:15], s44 offen lds
    v_mfma_f32_16x16x32_bf16 v[108:111], a[156:159], v[156:159], v[108:111]
    ds_read_b64_tr_b16 v[126:127], v27 offset:18944
    ds_read_b128 a[164:167], v18 offset:2048
    v_mfma_f32_16x16x32_bf16 v[92:95], a[156:159], v[152:155], v[92:95]
    ds_read_b128 a[168:171], v18 offset:4096
    ds_read_b128 a[172:175], v18 offset:6144
    v_mfma_f32_16x16x32_bf16 v[76:79], a[156:159], v[148:151], v[76:79]
    ds_read_b32 v38, v33 offset:0
    v_cmp_eq_u32 vcc, 0, v4
    s_cbranch_vccnz L_ns2
L_no3:
    s_cmp_lg_u32 s3, 0
    s_cbranch_scc1 L_nf14
    s_mov_b64 exec, 0xff
    s_add_u32 s57, s42, 32768
    buffer_store_dwordx4 v[4:7], v16, s[20:23], s57 offen sc1
    s_mov_b64 exec, -1
L_nf14:
    v_mfma_f32_16x16x32_bf16 v[60:63], a[156:159], v[144:147], v[60:63]
    buffer_load_dwordx4 v15, s[12:15], s44 offen offset:1024 lds
    s_add_u32 s98, s98, 1
    s_and_b32 s98, s98, 7
    v_dot2c_f32_bf16 v36, v37, v44
    s_waitcnt lgkmcnt(6)
    v_mfma_f32_16x16x32_bf16 v[48:51], a[160:163], v[112:115], v[48:51]
    v_mfma_f32_16x16x32_bf16 v[64:67], a[160:163], v[116:119], v[64:67]
    v_mfma_f32_16x16x32_bf16 v[80:83], a[160:163], v[120:123], v[80:83]
    s_waitcnt lgkmcnt(0)
    v_mfma_f32_16x16x32_bf16 v[96:99], a[160:163], v[124:127], v[96:99]
    s_add_u32 m0, s45, 100352
    s_mul_i32 s44, s98, 196608
    s_add_u32 s44, s44, s41
    buffer_load_dwordx4 v14, s[12:15], s44 offen lds
    v_mfma_f32_16x16x32_bf16 v[100:103], a[164:167], v[124:127], v[100:103]
    v_mfma_f32_16x16x32_bf16 v[84:87], a[164:167], v[120:123], v[84:87]
    v_mfma_f32_16x16x32_bf16 v[68:71], a[164:167], v[116:119], v[68:71]
    ds_read_b128 a[176:179], v21 offset:0
    ds_read_b64_tr_b16 v[144:145], v24 offset:24576
    v_mfma_f32_16x16x32_bf16 v[52:55], a[164:167], v[112:115], v[52:55]
    buffer_load_dwordx4 v15, s[12:15], s44 offen offset:1024 lds
    s_add_u32 s98, s98, 1
    s_and_b32 s98, s98, 7
    v_mfma_f32_16x16x32_bf16 v[56:59], a[168:171], v[112:115], v[56:59]
    ds_read_b64_tr_b16 v[146:147], v24 offset:25088
    ds_read_b64_tr_b16 v[148:149], v27 offset:24576
    v_mfma_f32_16x16x32_bf16 v[72:75], a[168:171], v[116:119], v[72:75]
    ds_read_b64_tr_b16 v[150:151], v27 offset:25088
    ds_read_b64_tr_b16 v[152:153], v24 offset:26624
    v_mfma_f32_16x16x32_bf16 v[88:91], a[168:171], v[120:123], v[88:91]
    ds_read_b64_tr_b16 v[154:155], v24 offset:27136
    ds_read_b64_tr_b16 v[156:157], v27 offset:26624
    v_mfma_f32_16x16x32_bf16 v[104:107], a[168:171], v[124:127], v[104:107]
    v_mfma_f32_16x16x32_bf16 v[108:111], a[172:175], v[124:127], v[108:111]
    ds_read_b64_tr_b16 v[158:159], v27 offset:27136
    ds_read_b128 a[180:183], v21 offset:2048
    v_mfma_f32_16x16x32_bf16 v[92:95], a[172:175], v[120:123], v[92:95]
    ds_read_b128 a[184:187], v21 offset:4096
    ds_read_b128 a[188:191], v21 offset:6144
    v_mfma_f32_16x16x32_bf16 v[76:79], a[172:175], v[116:119], v[76:79]
    v_mfma_f32_16x16x32_bf16 v[60:63], a[172:175], v[112:115], v[60:63]
    s_waitcnt lgkmcnt(5)
    v_mfma_f32_16x16x32_bf16 v[48:51], a[176:179], v[144:147], v[48:51]
    v_mfma_f32_16x16x32_bf16 v[64:67], a[176:179], v[148:151], v[64:67]
    v_mfma_f32_16x16x32_bf16 v[80:83], a[176:179], v[152:155], v[80:83]
    s_waitcnt lgkmcnt(0)
    v_mfma_f32_16x16x32_bf16 v[96:99], a[176:179], v[156:159], v[96:99]
    v_mfma_f32_16x16x32_bf16 v[100:103], a[180:183], v[156:159], v[100:103]
    v_mfma_f32_16x16x32_bf16 v[84:87], a[180:183], v[152:155], v[84:87]
    s_waitcnt vmcnt(12)
    s_barrier
    v_mfma_f32_16x16x32_bf16 v[68:71], a[180:183], v[148:151], v[68:71]
    ds_read_b128 a[192:195], v18 offset:32768
    ds_read_b64_tr_b16 v[112:113], v24 offset:49152
    v_mfma_f32_16x16x32_bf16 v[52:55], a[180:183], v[144:147], v[52:55]
    s_add_u32 m0, s45, 16384
    s_add_u32 s58, s60, s100
    buffer_load_dwordx4 v128, s[16:19], s58 offen offset:0 lds
    v_mfma_f32_16x16x32_bf16 v[56:59], a[184:187], v[144:147], v[56:59]
    ds_read_b64_tr_b16 v[114:115], v24 offset:49664
    ds_read_b64_tr_b16 v[116:117], v27 offset:49152
    v_mfma_f32_16x16x32_bf16 v[72:75], a[184:187], v[148:151], v[72:75]
    ds_read_b64_tr_b16 v[118:119], v27 offset:49664
    ds_read_b64_tr_b16 v[120:121], v24 offset:51200
    v_mfma_f32_16x16x32_bf16 v[88:91], a[184:187], v[152:155], v[88:91]
    ds_read_b64_tr_b16 v[122:123], v24 offset:51712
    ds_read_b64_tr_b16 v[124:125], v27 offset:51200
    v_mfma_f32_16x16x32_bf16 v[104:107], a[184:187], v[156:159], v[104:107]
    buffer_load_dwordx4 v129, s[16:19], s58 offen offset:1024 lds
    v_mfma_f32_16x16x32_bf16 v[108:111], a[188:191], v[156:159], v[108:111]
    ds_read_b64_tr_b16 v[126:127], v27 offset:51712
    ds_read_b128 a[196:199], v18 offset:34816
    v_mfma_f32_16x16x32_bf16 v[92:95], a[188:191], v[152:155], v[92:95]
    ds_read_b128 a[200:203], v18 offset:36864
    ds_read_b128 a[204:207], v18 offset:38912
    v_mfma_f32_16x16x32_bf16 v[76:79], a[188:191], v[148:151], v[76:79]
    ds_read_b32 v37, v33 offset:32768
    v_mfma_f32_16x16x32_bf16 v[60:63], a[188:191], v[144:147], v[60:63]
    buffer_load_dwordx4 v130, s[16:19], s58 offen offset:2048 lds
    v_dot2c_f32_bf16 v36, v38, v45
    s_waitcnt lgkmcnt(6)
    v_mfma_f32_16x16x32_bf16 v[48:51], a[192:195], v[112:115], v[48:51]
    v_mfma_f32_16x16x32_bf16 v[64:67], a[192:195], v[116:119], v[64:67]
    v_mfma_f32_16x16x32_bf16 v[80:83], a[192:195], v[120:123], v[80:83]
    s_waitcnt lgkmcnt(0)
    v_mfma_f32_16x16x32_bf16 v[96:99], a[192:195], v[124:127], v[96:99]
    buffer_load_dwordx4 v131, s[16:19], s58 offen offset:3072 lds
    s_add_u32 s100, s100, 65536
    s_and_b32 s100, s100, 0x7ffff
    v_mfma_f32_16x16x32_bf16 v[100:103], a[196:199], v[124:127], v[100:103]
    v_mfma_f32_16x16x32_bf16 v[84:87], a[196:199], v[120:123], v[84:87]
    v_mfma_f32_16x16x32_bf16 v[68:71], a[196:199], v[116:119], v[68:71]
    ds_read_b128 a[208:211], v21 offset:32768
    ds_read_b64_tr_b16 v[144:145], v24 offset:57344
    v_mfma_f32_16x16x32_bf16 v[52:55], a[196:199], v[112:115], v[52:55]
    s_add_u32 m0, s45, 114688
    s_mul_i32 s44, s98, 196608
    s_add_u32 s44, s44, s41
    buffer_load_dwordx4 v14, s[12:15], s44 offen lds
    v_mfma_f32_16x16x32_bf16 v[56:59], a[200:203], v[112:115], v[56:59]
    ds_read_b64_tr_b16 v[146:147], v24 offset:57856
    ds_read_b64_tr_b16 v[148:149], v27 offset:57344
    v_mfma_f32_16x16x32_bf16 v[72:75], a[200:203], v[116:119], v[72:75]
    ds_read_b64_tr_b16 v[150:151], v27 offset:57856
    ds_read_b64_tr_b16 v[152:153], v24 offset:59392
    v_mfma_f32_16x16x32_bf16 v[88:91], a[200:203], v[120:123], v[88:91]
    ds_read_b64_tr_b16 v[154:155], v24 offset:59904
    ds_read_b64_tr_b16 v[156:157], v27 offset:59392
    v_mfma_f32_16x16x32_bf16 v[104:107], a[200:203], v[124:127], v[104:107]
    buffer_load_dwordx4 v15, s[12:15], s44 offen offset:1024 lds
    s_add_u32 s98, s98, 1
    s_and_b32 s98, s98, 7
    v_mfma_f32_16x16x32_bf16 v[108:111], a[204:207], v[124:127], v[108:111]
    ds_read_b64_tr_b16 v[158:159], v27 offset:59904
    ds_read_b128 a[212:215], v21 offset:34816
    v_mfma_f32_16x16x32_bf16 v[92:95], a[204:207], v[120:123], v[92:95]
    ds_read_b128 a[216:219], v21 offset:36864
    ds_read_b128 a[220:223], v21 offset:38912
    v_mfma_f32_16x16x32_bf16 v[76:79], a[204:207], v[116:119], v[76:79]
    v_mfma_f32_16x16x32_bf16 v[60:63], a[204:207], v[112:115], v[60:63]
    s_add_u32 m0, s45, 116736
    s_mul_i32 s44, s98, 196608
    s_add_u32 s44, s44, s41
    buffer_load_dwordx4 v14, s[12:15], s44 offen lds
    s_waitcnt lgkmcnt(5)
    v_mfma_f32_16x16x32_bf16 v[48:51], a[208:211], v[144:147], v[48:51]
    v_mfma_f32_16x16x32_bf16 v[64:67], a[208:211], v[148:151], v[64:67]
    v_mfma_f32_16x16x32_bf16 v[80:83], a[208:211], v[152:155], v[80:83]
    s_waitcnt lgkmcnt(0)
    v_mfma_f32_16x16x32_bf16 v[96:99], a[208:211], v[156:159], v[96:99]
    buffer_load_dwordx4 v15, s[12:15], s44 offen offset:1024 lds
    s_add_u32 s98, s98, 1
    s_and_b32 s98, s98, 7
    v_mfma_f32_16x16x32_bf16 v[100:103], a[212:215], v[156:159], v[100:103]
    v_mfma_f32_16x16x32_bf16 v[84:87], a[212:215], v[152:155], v[84:87]
    s_waitcnt vmcnt(12)
    s_barrier
    v_mfma_f32_16x16x32_bf16 v[68:71], a[212:215], v[148:151], v[68:71]
    ds_read_b128 a[224:227], v19 offset:0
    ds_read_b64_tr_b16 v[112:113], v25 offset:16384
    v_mfma_f32_16x16x32_bf16 v[52:55], a[212:215], v[144:147], v[52:55]
    s_add_u32 m0, s45, 131072
    s_mul_i32 s44, s98, 196608
    s_add_u32 s44, s44, s41
    buffer_load_dwordx4 v14, s[12:15], s44 offen lds
    v_mfma_f32_16x16x32_bf16 v[56:59], a[216:219], v[144:147], v[56:59]
    ds_read_b64_tr_b16 v[114:115], v25 offset:16896
    ds_read_b64_tr_b16 v[116:117], v28 offset:16384
    v_mfma_f32_16x16x32_bf16 v[72:75], a[216:219], v[148:151], v[72:75]
    ds_read_b64_tr_b16 v[118:119], v28 offset:16896
    ds_read_b64_tr_b16 v[120:121], v25 offset:18432
    v_mfma_f32_16x16x32_bf16 v[88:91], a[216:219], v[152:155], v[88:91]
    ds_read_b64_tr_b16 v[122:123], v25 offset:18944
    ds_read_b64_tr_b16 v[124:125], v28 offset:18432
    v_mfma_f32_16x16x32_bf16 v[104:107], a[216:219], v[156:159], v[104:107]
    buffer_load_dwordx4 v15, s[12:15], s44 offen offset:1024 lds
    s_add_u32 s98, s98, 1
    s_and_b32 s98, s98, 7
    v_mfma_f32_16x16x32_bf16 v[108:111], a[220:223], v[156:159], v[108:111]
    ds_read_b64_tr_b16 v[126:127], v28 offset:18944
    ds_read_b128 a[228:231], v19 offset:2048
    v_mfma_f32_16x16x32_bf16 v[92:95], a[220:223], v[152:155], v[92:95]
    ds_read_b128 a[232:235], v19 offset:4096
    ds_read_b128 a[236:239], v19 offset:6144
    v_mfma_f32_16x16x32_bf16 v[76:79], a[220:223], v[148:151], v[76:79]
    ds_read_b32 v38, v34 offset:0
    v_mfma_f32_16x16x32_bf16 v[60:63], a[220:223], v[144:147], v[60:63]
    s_add_u32 m0, s45, 133120
    s_mul_i32 s44, s98, 196608
    s_add_u32 s44, s44, s41
    buffer_load_dwordx4 v14, s[12:15], s44 offen lds
    v_dot2c_f32_bf16 v36, v37, v46
    s_waitcnt lgkmcnt(6)
    v_mfma_f32_16x16x32_bf16 v[48:51], a[224:227], v[112:115], v[48:51]
    v_mfma_f32_16x16x32_bf16 v[64:67], a[224:227], v[116:119], v[64:67]
    buffer_load_dwordx4 v15, s[12:15], s44 offen offset:1024 lds
    s_add_u32 s98, s98, 1
    s_and_b32 s98, s98, 7
    s_waitcnt lgkmcnt(0)
    v_dot2c_f32_bf16 v36, v38, v47
    v_mfma_f32_16x16x32_bf16 v[80:83], a[224:227], v[120:123], v[80:83]
    v_mfma_f32_16x16x32_bf16 v[96:99], a[224:227], v[124:127], v[96:99]
    s_add_u32 m0, s45, 147456
    s_mul_i32 s44, s98, 196608
    s_add_u32 s44, s44, s41
    buffer_load_dwordx4 v14, s[12:15], s44 offen lds
    v_mfma_f32_16x16x32_bf16 v[100:103], a[228:231], v[124:127], v[100:103]
    v_add_f32_dpp v36, v36, v36 row_shr:1 row_mask:0xf bank_mask:0xf bound_ctrl:0
    v_mfma_f32_16x16x32_bf16 v[84:87], a[228:231], v[120:123], v[84:87]
    v_mfma_f32_16x16x32_bf16 v[68:71], a[228:231], v[116:119], v[68:71]
    ds_read_b128 a[240:243], v22 offset:0
    ds_read_b64_tr_b16 v[144:145], v25 offset:24576
    v_add_f32_dpp v36, v36, v36 row_shr:2 row_mask:0xf bank_mask:0xf bound_ctrl:0
    v_mfma_f32_16x16x32_bf16 v[52:55], a[228:231], v[112:115], v[52:55]
    buffer_load_dwordx4 v15, s[12:15], s44 offen offset:1024 lds
    s_add_u32 s98, s98, 1
    s_and_b32 s98, s98, 7
    v_mfma_f32_16x16x32_bf16 v[56:59], a[232:235], v[112:115], v[56:59]
    ds_read_b64_tr_b16 v[146:147], v25 offset:25088
    ds_read_b64_tr_b16 v[148:149], v28 offset:24576
    v_add_f32_dpp v36, v36, v36 row_shr:4 row_mask:0xf bank_mask:0xf bound_ctrl:0
    v_mfma_f32_16x16x32_bf16 v[72:75], a[232:235], v[116:119], v[72:75]
    ds_read_b64_tr_b16 v[150:151], v28 offset:25088
    ds_read_b64_tr_b16 v[152:153], v25 offset:26624
    v_mfma_f32_16x16x32_bf16 v[88:91], a[232:235], v[120:123], v[88:91]
    ds_read_b64_tr_b16 v[154:155], v25 offset:27136
    ds_read_b64_tr_b16 v[156:157], v28 offset:26624
    v_add_f32_dpp v36, v36, v36 row_shr:8 row_mask:0xf bank_mask:0xf bound_ctrl:0
    v_mfma_f32_16x16x32_bf16 v[104:107], a[232:235], v[124:127], v[104:107]
    s_add_u32 m0, s45, 149504
    s_mul_i32 s44, s98, 196608
    s_add_u32 s44, s44, s41
    buffer_load_dwordx4 v14, s[12:15], s44 offen lds
    v_mfma_f32_16x16x32_bf16 v[108:111], a[236:239], v[124:127], v[108:111]
    ds_read_b64_tr_b16 v[158:159], v28 offset:27136
    ds_read_b128 a[244:247], v22 offset:2048
    v_add_f32_dpp v36, v36, v36 row_bcast:15 row_mask:0xa bank_mask:0xf
    v_mul_f32 v36, 0xbfb8aa3b, v36
    v_mfma_f32_16x16x32_bf16 v[92:95], a[236:239], v[120:123], v[92:95]
    ds_read_b128 a[248:251], v22 offset:4096
    ds_read_b128 a[252:255], v22 offset:6144
    v_mfma_f32_16x16x32_bf16 v[76:79], a[236:239], v[116:119], v[76:79]
    v_exp_f32 v36, v36
    v_mfma_f32_16x16x32_bf16 v[60:63], a[236:239], v[112:115], v[60:63]
    buffer_load_dwordx4 v15, s[12:15], s44 offen offset:1024 lds
    s_waitcnt lgkmcnt(5)
    v_mfma_f32_16x16x32_bf16 v[48:51], a[240:243], v[144:147], v[48:51]
    v_add_f32 v36, 1.0, v36
    v_mfma_f32_16x16x32_bf16 v[64:67], a[240:243], v[148:151], v[64:67]
    v_mfma_f32_16x16x32_bf16 v[80:83], a[240:243], v[152:155], v[80:83]
    v_rcp_f32 v36, v36
    s_waitcnt lgkmcnt(0)
    v_mfma_f32_16x16x32_bf16 v[96:99], a[240:243], v[156:159], v[96:99]
    buffer_store_dwordx4 v[244:247], v16, s[20:23], s55 offen offset:0 sc1
    v_mfma_f32_16x16x32_bf16 v[100:103], a[244:247], v[156:159], v[100:103]
    v_mfma_f32_16x16x32_bf16 v[84:87], a[244:247], v[152:155], v[84:87]
    v_mfma_f32_16x16x32_bf16 v[68:71], a[244:247], v[148:151], v[68:71]
    v_mfma_f32_16x16x32_bf16 v[52:55], a[244:247], v[144:147], v[52:55]
    buffer_store_dwordx4 v[244:247], v16, s[20:23], s55 offen offset:1024 sc1
    v_mfma_f32_16x16x32_bf16 v[56:59], a[248:251], v[144:147], v[56:59]
    v_mfma_f32_16x16x32_bf16 v[72:75], a[248:251], v[148:151], v[72:75]
    v_mfma_f32_16x16x32_bf16 v[88:91], a[248:251], v[152:155], v[88:91]
    v_mfma_f32_16x16x32_bf16 v[104:107], a[248:251], v[156:159], v[104:107]
    buffer_store_dwordx4 v[244:247], v16, s[20:23], s61 offen offset:0 sc1
    v_mfma_f32_16x16x32_bf16 v[108:111], a[252:255], v[156:159], v[108:111]
    v_mfma_f32_16x16x32_bf16 v[92:95], a[252:255], v[152:155], v[92:95]
    v_mfma_f32_16x16x32_bf16 v[76:79], a[252:255], v[148:151], v[76:79]
    v_mfma_f32_16x16x32_bf16 v[60:63], a[252:255], v[144:147], v[60:63]
    s_mov_b32 exec_lo, 0xf0000000
    s_mov_b32 exec_hi, 0xf0000000
    buffer_store_dwordx4 v[36:39], v3, s[20:23], s56 offen sc1
    s_mov_b64 exec, -1
    v_mov_b32 v8, -1
    v_mov_b32 v9, -1
    v_mov_b32 v10, -1
    v_mov_b32 v11, -1
    buffer_load_dwordx2 v[40:41], v17, s[20:23], 0 offen sc1
    v_pk_mul_f32 v[244:245], v[48:49], s[50:51]
    v_pk_mul_f32 v[246:247], v[50:51], s[50:51]
    v_pk_mul_f32 v[248:249], v[52:53], s[50:51]
    v_pk_mul_f32 v[250:251], v[54:55], s[50:51]
    v_exp_f32_e64 v244, v244 clamp
    v_exp_f32_e64 v245, v245 clamp
    v_max_f32 v48, s52, v48
    v_max_f32 v49, s52, v49
    v_exp_f32_e64 v246, v246 clamp
    v_exp_f32_e64 v247, v247 clamp
    v_max_f32 v50, s52, v50
    v_max_f32 v51, s52, v51
    v_exp_f32_e64 v248, v248 clamp
    v_exp_f32_e64 v249, v249 clamp
    v_max_f32 v52, s52, v52
    v_max_f32 v53, s52, v53
    v_exp_f32_e64 v250, v250 clamp
    v_exp_f32_e64 v251, v251 clamp
    v_max_f32 v54, s52, v54
    v_max_f32 v55, s52, v55
    v_pk_add_f32 v[48:49], v[48:49], v[244:245]
    v_pk_add_f32 v[50:51], v[50:51], v[246:247]
    v_pk_add_f32 v[52:53], v[52:53], v[248:249]
    v_pk_add_f32 v[54:55], v[54:55], v[250:251]
    v_cvt_pk_bf16_f32 v192, v80, v81
    v_cvt_pk_bf16_f32 v193, v82, v83
    v_cvt_pk_bf16_f32 v194, v84, v85
    v_cvt_pk_bf16_f32 v195, v86, v87
    v_cvt_pk_bf16_f32 v176, v48, v49
    v_cvt_pk_bf16_f32 v177, v50, v51
    buffer_store_dwordx4 v[8:11], v16, s[20:23], s61 offen offset:1024 sc1
    v_cvt_pk_bf16_f32 v178, v52, v53
    v_cvt_pk_bf16_f32 v179, v54, v55
    v_pk_mul_f32 v[244:245], v[56:57], s[50:51]
    v_pk_mul_f32 v[246:247], v[58:59], s[50:51]
    v_pk_mul_f32 v[248:249], v[60:61], s[50:51]
    v_pk_mul_f32 v[250:251], v[62:63], s[50:51]
    v_mfma_f32_16x16x32_bf16 v[208:211], v[176:179], v[192:195], 0
    v_exp_f32_e64 v244, v244 clamp
    v_mfma_f32_16x16x32_bf16 v[216:219], v[176:179], v[240:243], 0
    v_exp_f32_e64 v245, v245 clamp
    v_max_f32 v56, s52, v56
    v_max_f32 v57, s52, v57
    v_exp_f32_e64 v246, v246 clamp
    v_exp_f32_e64 v247, v247 clamp
    v_max_f32 v58, s52, v58
    v_max_f32 v59, s52, v59
    v_exp_f32_e64 v248, v248 clamp
    v_exp_f32_e64 v249, v249 clamp
    v_max_f32 v60, s52, v60
    v_max_f32 v61, s52, v61
    v_exp_f32_e64 v250, v250 clamp
    v_exp_f32_e64 v251, v251 clamp
    v_max_f32 v62, s52, v62
    v_max_f32 v63, s52, v63
    v_pk_add_f32 v[56:57], v[56:57], v[244:245]
    v_pk_add_f32 v[58:59], v[58:59], v[246:247]
    v_pk_add_f32 v[60:61], v[60:61], v[248:249]
    v_pk_add_f32 v[62:63], v[62:63], v[250:251]
    v_cvt_pk_bf16_f32 v196, v88, v89
    v_cvt_pk_bf16_f32 v197, v90, v91
    v_cvt_pk_bf16_f32 v198, v92, v93
    v_cvt_pk_bf16_f32 v199, v94, v95
    v_cvt_pk_bf16_f32 v180, v56, v57
    s_waitcnt vmcnt(6)
    s_barrier
    ds_read_b64_tr_b16 v[112:113], v25 offset:32768
    ds_read_b64_tr_b16 v[114:115], v25 offset:33280
    ds_read_b64_tr_b16 v[116:117], v28 offset:32768
    ds_read_b64_tr_b16 v[118:119], v28 offset:33280
    v_cvt_pk_bf16_f32 v181, v58, v59
    v_cvt_pk_bf16_f32 v182, v60, v61
    v_cvt_pk_bf16_f32 v183, v62, v63
    v_pk_mul_f32 v[244:245], v[64:65], s[50:51]
    v_pk_mul_f32 v[246:247], v[66:67], s[50:51]
    v_pk_mul_f32 v[248:249], v[68:69], s[50:51]
    v_pk_mul_f32 v[250:251], v[70:71], s[50:51]
    v_mfma_f32_16x16x32_bf16 v[208:211], v[180:183], v[196:199], v[208:211]
    v_exp_f32_e64 v244, v244 clamp
    v_mfma_f32_16x16x32_bf16 v[216:219], v[180:183], v[240:243], v[216:219]
    v_exp_f32_e64 v245, v245 clamp
    v_max_f32 v64, s52, v64
    v_max_f32 v65, s52, v65
    v_exp_f32_e64 v246, v246 clamp
    v_exp_f32_e64 v247, v247 clamp
    v_max_f32 v66, s52, v66
    v_max_f32 v67, s52, v67
    v_exp_f32_e64 v248, v248 clamp
    v_exp_f32_e64 v249, v249 clamp
    v_max_f32 v68, s52, v68
    v_max_f32 v69, s52, v69
    ds_write_b128 v140, v[208:211] offset:0
    v_exp_f32_e64 v250, v250 clamp
    v_exp_f32_e64 v251, v251 clamp
    v_max_f32 v70, s52, v70
    v_max_f32 v71, s52, v71
    v_pk_add_f32 v[64:65], v[64:65], v[244:245]
    v_pk_add_f32 v[66:67], v[66:67], v[246:247]
    ds_write_b128 v142, v[216:219] offset:0
    v_pk_add_f32 v[68:69], v[68:69], v[248:249]
    v_pk_add_f32 v[70:71], v[70:71], v[250:251]
    v_cvt_pk_bf16_f32 v200, v96, v97
    v_cvt_pk_bf16_f32 v201, v98, v99
    v_cvt_pk_bf16_f32 v202, v100, v101
    v_cvt_pk_bf16_f32 v203, v102, v103
    v_cvt_pk_bf16_f32 v184, v64, v65
    v_cvt_pk_bf16_f32 v185, v66, v67
    v_cvt_pk_bf16_f32 v186, v68, v69
    v_cvt_pk_bf16_f32 v187, v70, v71
    v_pk_mul_f32 v[244:245], v[72:73], s[50:51]
    v_pk_mul_f32 v[246:247], v[74:75], s[50:51]
    v_pk_mul_f32 v[248:249], v[76:77], s[50:51]
    v_pk_mul_f32 v[250:251], v[78:79], s[50:51]
    v_mfma_f32_16x16x32_bf16 v[212:215], v[184:187], v[200:203], 0
    v_exp_f32_e64 v244, v244 clamp
    v_mfma_f32_16x16x32_bf16 v[220:223], v[184:187], v[240:243], 0
    v_exp_f32_e64 v245, v245 clamp
    v_max_f32 v72, s52, v72
    v_max_f32 v73, s52, v73
    v_exp_f32_e64 v246, v246 clamp
    v_exp_f32_e64 v247, v247 clamp
    v_max_f32 v74, s52, v74
    v_max_f32 v75, s52, v75
    v_exp_f32_e64 v248, v248 clamp
    v_exp_f32_e64 v249, v249 clamp
    v_max_f32 v76, s52, v76
    v_max_f32 v77, s52, v77
    v_exp_f32_e64 v250, v250 clamp
    v_exp_f32_e64 v251, v251 clamp
    v_max_f32 v78, s52, v78
    v_max_f32 v79, s52, v79
    v_pk_add_f32 v[72:73], v[72:73], v[244:245]
    v_pk_add_f32 v[74:75], v[74:75], v[246:247]
    v_pk_add_f32 v[76:77], v[76:77], v[248:249]
    v_pk_add_f32 v[78:79], v[78:79], v[250:251]
    v_cvt_pk_bf16_f32 v204, v104, v105
    v_cvt_pk_bf16_f32 v205, v106, v107
    v_cvt_pk_bf16_f32 v206, v108, v109
    v_cvt_pk_bf16_f32 v207, v110, v111
    v_cvt_pk_bf16_f32 v188, v72, v73
    v_cvt_pk_bf16_f32 v189, v74, v75
    v_cvt_pk_bf16_f32 v190, v76, v77
    v_cvt_pk_bf16_f32 v191, v78, v79
    s_nop 1
    v_mfma_f32_16x16x32_bf16 v[212:215], v[188:191], v[204:207], v[212:215]
    v_mfma_f32_16x16x32_bf16 v[220:223], v[188:191], v[240:243], v[220:223]
    s_waitcnt lgkmcnt(4)
    v_mfma_f32_16x16x32_bf16 v[144:147], v[112:115], a[0:3], 0
    ds_read_b64_tr_b16 v[120:121], v25 offset:40960
    v_mfma_f32_16x16x32_bf16 v[152:155], v[112:115], a[4:7], 0
    ds_read_b64_tr_b16 v[122:123], v25 offset:41472
    v_mfma_f32_16x16x32_bf16 v[160:163], v[112:115], a[8:11], 0
    v_mfma_f32_16x16x32_bf16 v[168:171], v[112:115], a[12:15], 0
    ds_write_b128 v140, v[212:215] offset:1024
    ds_write_b128 v142, v[220:223] offset:64
    s_waitcnt lgkmcnt(6)
    v_mfma_f32_16x16x32_bf16 v[148:151], v[116:119], a[0:3], 0
    ds_read_b64_tr_b16 v[124:125], v28 offset:40960
    v_mfma_f32_16x16x32_bf16 v[156:159], v[116:119], a[4:7], 0
    ds_read_b64_tr_b16 v[126:127], v28 offset:41472
    v_mfma_f32_16x16x32_bf16 v[164:167], v[116:119], a[8:11], 0
    s_waitcnt vmcnt(0) lgkmcnt(0)
    s_barrier
    ds_read_b128 v[80:83], v141 offset:0
    ds_read_b128 v[84:87], v141 offset:1024
    ds_read_b128 v[88:91], v143
    ds_read_b128 v[92:95], v143 offset:256
    v_mfma_f32_16x16x32_bf16 v[172:175], v[116:119], a[12:15], 0
    v_mfma_f32_16x16x32_bf16 v[144:147], v[120:123], a[16:19], v[144:147]
    ds_read_b64_tr_b16 v[112:113], v25 offset:34816
    v_mfma_f32_16x16x32_bf16 v[152:155], v[120:123], a[20:23], v[152:155]
    ds_read_b64_tr_b16 v[114:115], v25 offset:35328
    v_mfma_f32_16x16x32_bf16 v[160:163], v[120:123], a[24:27], v[160:163]
    v_mfma_f32_16x16x32_bf16 v[168:171], v[120:123], a[28:31], v[168:171]
    s_waitcnt lgkmcnt(5)
    v_pk_add_f32 v[80:81], v[80:81], v[208:209]
    v_pk_add_f32 v[82:83], v[82:83], v[210:211]
    s_waitcnt lgkmcnt(4)
    v_pk_add_f32 v[84:85], v[84:85], v[212:213]
    v_pk_add_f32 v[86:87], v[86:87], v[214:215]
    s_waitcnt lgkmcnt(2)
    v_pk_add_f32 v[88:89], v[88:89], v[92:93]
    v_pk_add_f32 v[90:91], v[90:91], v[94:95]
    v_cvt_pk_bf16_f32 v92, v80, v81
    v_cvt_pk_bf16_f32 v93, v82, v83
    v_cvt_pk_bf16_f32 v94, v84, v85
    v_cvt_pk_bf16_f32 v95, v86, v87
    s_mov_b64 exec, s[6:7]
    buffer_store_dwordx4 v[92:95], v16, s[20:23], s53 offen sc1
    s_mov_b64 exec, 0xff
    buffer_store_dwordx4 v[88:91], v16, s[20:23], s54 offen sc1
    s_cmp_lg_u32 s3, 0
    s_cbranch_scc1 L_nf5
    buffer_store_dwordx4 v[4:7], v16, s[20:23], s42 offen sc1
L_nf5:
    s_mov_b64 exec, -1
    v_mfma_f32_16x16x32_bf16 v[148:151], v[124:127], a[16:19], v[148:151]
    ds_read_b64_tr_b16 v[116:117], v28 offset:34816
    v_xor_b32 v100, 0, v30
    v_mfma_f32_16x16x32_bf16 v[156:159], v[124:127], a[20:23], v[156:159]
    ds_read_b64_tr_b16 v[118:119], v28 offset:35328
    v_add_u32 v101, 65536, v100
    v_mfma_f32_16x16x32_bf16 v[164:167], v[124:127], a[24:27], v[164:167]
    v_add_u32 v102, 131072, v100
    v_mfma_f32_16x16x32_bf16 v[172:175], v[124:127], a[28:31], v[172:175]
    s_add_u32 m0, s45, 32768
    s_add_u32 s58, s60, s100
    buffer_load_dwordx4 v128, s[16:19], s58 offen offset:0 lds
    s_waitcnt lgkmcnt(2)
    v_mfma_f32_16x16x32_bf16 v[144:147], v[112:115], a[32:35], v[144:147]
    ds_read_b64_tr_b16 v[120:121], v25 offset:43008
    v_xor_b32 v103, 32, v30
    v_mfma_f32_16x16x32_bf16 v[152:155], v[112:115], a[36:39], v[152:155]
    ds_read_b64_tr_b16 v[122:123], v25 offset:43520
    v_add_u32 v104, 65536, v103
    v_mfma_f32_16x16x32_bf16 v[160:163], v[112:115], a[40:43], v[160:163]
    v_add_u32 v105, 131072, v103
    v_mfma_f32_16x16x32_bf16 v[168:171], v[112:115], a[44:47], v[168:171]
    buffer_load_dwordx4 v129, s[16:19], s58 offen offset:1024 lds
    s_waitcnt lgkmcnt(2)
    v_mfma_f32_16x16x32_bf16 v[148:151], v[116:119], a[32:35], v[148:151]
    ds_read_b64_tr_b16 v[124:125], v28 offset:43008
    v_xor_b32 v106, 64, v30
    v_mfma_f32_16x16x32_bf16 v[156:159], v[116:119], a[36:39], v[156:159]
    ds_read_b64_tr_b16 v[126:127], v28 offset:43520
    v_add_u32 v107, 65536, v106
    v_mfma_f32_16x16x32_bf16 v[164:167], v[116:119], a[40:43], v[164:167]
    v_add_u32 v108, 131072, v106
    v_mfma_f32_16x16x32_bf16 v[172:175], v[116:119], a[44:47], v[172:175]
    buffer_load_dwordx4 v130, s[16:19], s58 offen offset:2048 lds
    s_waitcnt lgkmcnt(2)
    v_mfma_f32_16x16x32_bf16 v[144:147], v[120:123], a[48:51], v[144:147]
    ds_read_b64_tr_b16 v[112:113], v25 offset:49152
    v_xor_b32 v109, 96, v30
    v_mfma_f32_16x16x32_bf16 v[152:155], v[120:123], a[52:55], v[152:155]
    ds_read_b64_tr_b16 v[114:115], v25 offset:49664
    v_add_u32 v110, 65536, v109
    v_mfma_f32_16x16x32_bf16 v[160:163], v[120:123], a[56:59], v[160:163]
    v_add_u32 v111, 131072, v109
    v_mfma_f32_16x16x32_bf16 v[168:171], v[120:123], a[60:63], v[168:171]
    buffer_load_dwordx4 v131, s[16:19], s58 offen offset:3072 lds
    s_add_u32 s100, s100, 65536
    s_and_b32 s100, s100, 0x7ffff
    s_waitcnt lgkmcnt(2)
    v_mfma_f32_16x16x32_bf16 v[148:151], v[124:127], a[48:51], v[148:151]
    ds_read_b64_tr_b16 v[116:117], v28 offset:49152
    v_mov_b32 v218, 0
    v_mfma_f32_16x16x32_bf16 v[156:159], v[124:127], a[52:55], v[156:159]
    ds_read_b64_tr_b16 v[118:119], v28 offset:49664
    v_mov_b32 v219, 0
    v_mfma_f32_16x16x32_bf16 v[164:167], v[124:127], a[56:59], v[164:167]
    v_and_b32 v46, 0xf0, v16
    v_mfma_f32_16x16x32_bf16 v[172:175], v[124:127], a[60:63], v[172:175]
    s_add_u32 m0, s45, 49152
    s_add_u32 s58, s60, s100
    buffer_load_dwordx4 v128, s[16:19], s58 offen offset:0 lds
    s_waitcnt lgkmcnt(2)
    v_mfma_f32_16x16x32_bf16 v[144:147], v[112:115], a[64:67], v[144:147]
    ds_read_b64_tr_b16 v[120:121], v25 offset:57344
    v_lshlrev_b32 v46, 2, v46
    v_mfma_f32_16x16x32_bf16 v[152:155], v[112:115], a[68:71], v[152:155]
    ds_read_b64_tr_b16 v[122:123], v25 offset:57856
    v_mfma_f32_16x16x32_bf16 v[160:163], v[112:115], a[72:75], v[160:163]
    v_mfma_f32_16x16x32_bf16 v[168:171], v[112:115], a[76:79], v[168:171]
    buffer_load_dwordx4 v129, s[16:19], s58 offen offset:1024 lds
    s_waitcnt lgkmcnt(2)
    v_mfma_f32_16x16x32_bf16 v[148:151], v[116:119], a[64:67], v[148:151]
    ds_read_b64_tr_b16 v[124:125], v28 offset:57344
    v_mfma_f32_16x16x32_bf16 v[156:159], v[116:119], a[68:71], v[156:159]
    ds_read_b64_tr_b16 v[126:127], v28 offset:57856
    v_mfma_f32_16x16x32_bf16 v[164:167], v[116:119], a[72:75], v[164:167]
    v_mfma_f32_16x16x32_bf16 v[172:175], v[116:119], a[76:79], v[172:175]
    buffer_load_dwordx4 v130, s[16:19], s58 offen offset:2048 lds
    s_waitcnt lgkmcnt(2)
    v_mfma_f32_16x16x32_bf16 v[144:147], v[120:123], a[80:83], v[144:147]
    ds_read_b64_tr_b16 v[112:113], v25 offset:51200
    v_mfma_f32_16x16x32_bf16 v[152:155], v[120:123], a[84:87], v[152:155]
    ds_read_b64_tr_b16 v[114:115], v25 offset:51712
    v_mfma_f32_16x16x32_bf16 v[160:163], v[120:123], a[88:91], v[160:163]
    v_mfma_f32_16x16x32_bf16 v[168:171], v[120:123], a[92:95], v[168:171]
    buffer_load_dwordx4 v131, s[16:19], s58 offen offset:3072 lds
    s_add_u32 s100, s100, 65536
    s_and_b32 s100, s100, 0x7ffff
    s_waitcnt lgkmcnt(2)
    v_mfma_f32_16x16x32_bf16 v[148:151], v[124:127], a[80:83], v[148:151]
    ds_read_b64_tr_b16 v[116:117], v28 offset:51200
    v_mfma_f32_16x16x32_bf16 v[156:159], v[124:127], a[84:87], v[156:159]
    ds_read_b64_tr_b16 v[118:119], v28 offset:51712
    v_mfma_f32_16x16x32_bf16 v[164:167], v[124:127], a[88:91], v[164:167]
    v_mfma_f32_16x16x32_bf16 v[172:175], v[124:127], a[92:95], v[172:175]
    s_add_u32 m0, s45, 65536
    s_add_u32 s58, s60, s100
    buffer_load_dwordx4 v128, s[16:19], s58 offen offset:0 lds
    s_waitcnt lgkmcnt(2)
    v_mfma_f32_16x16x32_bf16 v[144:147], v[112:115], a[96:99], v[144:147]
    ds_read_b64_tr_b16 v[120:121], v25 offset:59392
    v_mfma_f32_16x16x32_bf16 v[152:155], v[112:115], a[100:103], v[152:155]
    ds_read_b64_tr_b16 v[122:123], v25 offset:59904
    v_mfma_f32_16x16x32_bf16 v[160:163], v[112:115], a[104:107], v[160:163]
    v_mfma_f32_16x16x32_bf16 v[168:171], v[112:115], a[108:111], v[168:171]
    buffer_load_dwordx4 v129, s[16:19], s58 offen offset:1024 lds
    s_waitcnt lgkmcnt(2)
    v_mfma_f32_16x16x32_bf16 v[148:151], v[116:119], a[96:99], v[148:151]
    ds_read_b64_tr_b16 v[124:125], v28 offset:59392
    v_mfma_f32_16x16x32_bf16 v[156:159], v[116:119], a[100:103], v[156:159]
    ds_read_b64_tr_b16 v[126:127], v28 offset:59904
    v_mfma_f32_16x16x32_bf16 v[164:167], v[116:119], a[104:107], v[164:167]
    v_mfma_f32_16x16x32_bf16 v[172:175], v[116:119], a[108:111], v[172:175]
    buffer_load_dwordx4 v130, s[16:19], s58 offen offset:2048 lds
    s_waitcnt lgkmcnt(2)
    v_mfma_f32_16x16x32_bf16 v[144:147], v[120:123], a[112:115], v[144:147]
    ds_read_b64_tr_b16 v[112:113], v26 offset:0
    v_mfma_f32_16x16x32_bf16 v[152:155], v[120:123], a[116:119], v[152:155]
    ds_read_b64_tr_b16 v[114:115], v26 offset:512
    v_mfma_f32_16x16x32_bf16 v[160:163], v[120:123], a[120:123], v[160:163]
    v_mfma_f32_16x16x32_bf16 v[168:171], v[120:123], a[124:127], v[168:171]
    buffer_load_dwordx4 v131, s[16:19], s58 offen offset:3072 lds
    s_add_u32 s100, s100, 65536
    s_and_b32 s100, s100, 0x7ffff
    s_waitcnt lgkmcnt(2)
    v_mfma_f32_16x16x32_bf16 v[148:151], v[124:127], a[112:115], v[148:151]
    ds_read_b64_tr_b16 v[116:117], v29 offset:0
    v_mfma_f32_16x16x32_bf16 v[156:159], v[124:127], a[116:119], v[156:159]
    ds_read_b64_tr_b16 v[118:119], v29 offset:512
    v_mfma_f32_16x16x32_bf16 v[164:167], v[124:127], a[120:123], v[164:167]
    v_mfma_f32_16x16x32_bf16 v[172:175], v[124:127], a[124:127], v[172:175]
    s_add_u32 m0, s45, 81920
    s_add_u32 s58, s60, s100
    buffer_load_dwordx4 v128, s[16:19], s58 offen offset:0 lds
    s_waitcnt lgkmcnt(2)
    v_mfma_f32_16x16x32_bf16 v[144:147], v[112:115], a[128:131], v[144:147]
    ds_read_b64_tr_b16 v[120:121], v26 offset:8192
    v_mfma_f32_16x16x32_bf16 v[152:155], v[112:115], a[132:135], v[152:155]
    ds_read_b64_tr_b16 v[122:123], v26 offset:8704
    v_mfma_f32_16x16x32_bf16 v[160:163], v[112:115], a[136:139], v[160:163]
    v_mfma_f32_16x16x32_bf16 v[168:171], v[112:115], a[140:143], v[168:171]
    s_barrier
    buffer_load_dwordx4 v129, s[16:19], s58 offen offset:1024 lds
    s_waitcnt lgkmcnt(2)
    v_mfma_f32_16x16x32_bf16 v[148:151], v[116:119], a[128:131], v[148:151]
    ds_read_b64_tr_b16 v[124:125], v29 offset:8192
    v_mfma_f32_16x16x32_bf16 v[156:159], v[116:119], a[132:135], v[156:159]
    ds_read_b64_tr_b16 v[126:127], v29 offset:8704
    v_mfma_f32_16x16x32_bf16 v[164:167], v[116:119], a[136:139], v[164:167]
    v_mfma_f32_16x16x32_bf16 v[172:175], v[116:119], a[140:143], v[172:175]
    s_waitcnt lgkmcnt(2)
    v_mfma_f32_16x16x32_bf16 v[144:147], v[120:123], a[144:147], v[144:147]
    ds_read_b64_tr_b16 v[112:113], v26 offset:2048
    v_mfma_f32_16x16x32_bf16 v[152:155], v[120:123], a[148:151], v[152:155]
    ds_read_b64_tr_b16 v[114:115], v26 offset:2560
    v_mfma_f32_16x16x32_bf16 v[160:163], v[120:123], a[152:155], v[160:163]
    v_mfma_f32_16x16x32_bf16 v[168:171], v[120:123], a[156:159], v[168:171]
    v_cmp_ne_u64 vcc, v[4:5], v[40:41]
    s_cbranch_vccnz L_fs6
L_fo7:
    buffer_load_dwordx4 v[208:211], v2, s[20:23], s63 offen sc1
    s_waitcnt lgkmcnt(2)
    v_mfma_f32_16x16x32_bf16 v[148:151], v[124:127], a[144:147], v[148:151]
    ds_read_b64_tr_b16 v[116:117], v29 offset:2048
    v_mfma_f32_16x16x32_bf16 v[156:159], v[124:127], a[148:151], v[156:159]
    ds_read_b64_tr_b16 v[118:119], v29 offset:2560
    v_mfma_f32_16x16x32_bf16 v[164:167], v[124:127], a[152:155], v[164:167]
    buffer_load_dwordx4 v[176:179], v16, s[20:23], s62 offen offset:0 sc1
    v_mfma_f32_16x16x32_bf16 v[172:175], v[124:127], a[156:159], v[172:175]
    s_waitcnt lgkmcnt(2)
    v_mfma_f32_16x16x32_bf16 v[144:147], v[112:115], a[160:163], v[144:147]
    ds_read_b64_tr_b16 v[120:121], v26 offset:10240
    v_mfma_f32_16x16x32_bf16 v[152:155], v[112:115], a[164:167], v[152:155]
    ds_read_b64_tr_b16 v[122:123], v26 offset:10752
    buffer_load_dwordx4 v[180:183], v16, s[20:23], s62 offen offset:1024 sc1
    v_mfma_f32_16x16x32_bf16 v[160:163], v[112:115], a[168:171], v[160:163]
    v_mfma_f32_16x16x32_bf16 v[168:171], v[112:115], a[172:175], v[168:171]
    s_waitcnt lgkmcnt(2)
    v_mfma_f32_16x16x32_bf16 v[148:151], v[116:119], a[160:163], v[148:151]
    ds_read_b64_tr_b16 v[124:125], v29 offset:10240
    buffer_load_dwordx4 v[184:187], v16, s[20:23], s62 offen offset:2048 sc1
    v_mfma_f32_16x16x32_bf16 v[156:159], v[116:119], a[164:167], v[156:159]
    ds_read_b64_tr_b16 v[126:127], v29 offset:10752
    v_mfma_f32_16x16x32_bf16 v[164:167], v[116:119], a[168:171], v[164:167]
    v_mfma_f32_16x16x32_bf16 v[172:175], v[116:119], a[172:175], v[172:175]
    buffer_load_dwordx4 v[188:191], v16, s[20:23], s62 offen offset:3072 sc1
    s_waitcnt lgkmcnt(2)
    v_mfma_f32_16x16x32_bf16 v[144:147], v[120:123], a[176:179], v[144:147]
    ds_read_b64_tr_b16 v[112:113], v26 offset:16384
    v_mfma_f32_16x16x32_bf16 v[152:155], v[120:123], a[180:183], v[152:155]
    ds_read_b64_tr_b16 v[114:115], v26 offset:16896
    v_mfma_f32_16x16x32_bf16 v[160:163], v[120:123], a[184:187], v[160:163]
    s_add_u32 s57, s62, 4096
    buffer_load_dwordx4 v[192:195], v16, s[20:23], s57 offen offset:0 sc1
    v_mfma_f32_16x16x32_bf16 v[168:171], v[120:123], a[188:191], v[168:171]
    s_waitcnt lgkmcnt(2)
    v_mfma_f32_16x16x32_bf16 v[148:151], v[124:127], a[176:179], v[148:151]
    ds_read_b64_tr_b16 v[116:117], v29 offset:16384
    v_mfma_f32_16x16x32_bf16 v[156:159], v[124:127], a[180:183], v[156:159]
    ds_read_b64_tr_b16 v[118:119], v29 offset:16896
    buffer_load_dwordx4 v[196:199], v16, s[20:23], s57 offen offset:1024 sc1
    v_mfma_f32_16x16x32_bf16 v[164:167], v[124:127], a[184:187], v[164:167]
    v_mfma_f32_16x16x32_bf16 v[172:175], v[124:127], a[188:191], v[172:175]
    s_waitcnt lgkmcnt(2)
    v_mfma_f32_16x16x32_bf16 v[144:147], v[112:115], a[192:195], v[144:147]
    ds_read_b64_tr_b16 v[120:121], v26 offset:24576
    buffer_load_dwordx4 v[200:203], v16, s[20:23], s57 offen offset:2048 sc1
    v_mfma_f32_16x16x32_bf16 v[152:155], v[112:115], a[196:199], v[152:155]
    ds_read_b64_tr_b16 v[122:123], v26 offset:25088
    v_mfma_f32_16x16x32_bf16 v[160:163], v[112:115], a[200:203], v[160:163]
    v_mfma_f32_16x16x32_bf16 v[168:171], v[112:115], a[204:207], v[168:171]
    buffer_load_dwordx4 v[204:207], v16, s[20:23], s57 offen offset:3072 sc1
    s_waitcnt lgkmcnt(2)
    v_mfma_f32_16x16x32_bf16 v[148:151], v[116:119], a[192:195], v[148:151]
    ds_read_b64_tr_b16 v[124:125], v29 offset:24576
    v_mfma_f32_16x16x32_bf16 v[156:159], v[116:119], a[196:199], v[156:159]
    ds_read_b64_tr_b16 v[126:127], v29 offset:25088
    v_mfma_f32_16x16x32_bf16 v[164:167], v[116:119], a[200:203], v[164:167]
    v_mfma_f32_16x16x32_bf16 v[172:175], v[116:119], a[204:207], v[172:175]
    s_waitcnt lgkmcnt(2)
    v_mfma_f32_16x16x32_bf16 v[144:147], v[120:123], a[208:211], v[144:147]
    ds_read_b64_tr_b16 v[112:113], v26 offset:18432
    v_mfma_f32_16x16x32_bf16 v[152:155], v[120:123], a[212:215], v[152:155]
    ds_read_b64_tr_b16 v[114:115], v26 offset:18944
    v_mfma_f32_16x16x32_bf16 v[160:163], v[120:123], a[216:219], v[160:163]
    v_mfma_f32_16x16x32_bf16 v[168:171], v[120:123], a[220:223], v[168:171]
    buffer_load_dwordx4 v130, s[16:19], s58 offen offset:2048 lds
    s_waitcnt lgkmcnt(2)
    v_mfma_f32_16x16x32_bf16 v[148:151], v[124:127], a[208:211], v[148:151]
    ds_read_b64_tr_b16 v[116:117], v29 offset:18432
    v_mfma_f32_16x16x32_bf16 v[156:159], v[124:127], a[212:215], v[156:159]
    ds_read_b64_tr_b16 v[118:119], v29 offset:18944
    v_mfma_f32_16x16x32_bf16 v[164:167], v[124:127], a[216:219], v[164:167]
    v_mfma_f32_16x16x32_bf16 v[172:175], v[124:127], a[220:223], v[172:175]
    buffer_load_dwordx4 v131, s[16:19], s58 offen offset:3072 lds
    s_add_u32 s100, s100, 65536
    s_and_b32 s100, s100, 0x7ffff
    s_waitcnt lgkmcnt(2)
    v_mfma_f32_16x16x32_bf16 v[144:147], v[112:115], a[224:227], v[144:147]
    ds_read_b64_tr_b16 v[120:121], v26 offset:26624
    v_mfma_f32_16x16x32_bf16 v[152:155], v[112:115], a[228:231], v[152:155]
    ds_read_b64_tr_b16 v[122:123], v26 offset:27136
    v_mfma_f32_16x16x32_bf16 v[160:163], v[112:115], a[232:235], v[160:163]
    v_mfma_f32_16x16x32_bf16 v[168:171], v[112:115], a[236:239], v[168:171]
    s_add_u32 m0, s45, 98304
    s_add_u32 s58, s60, s100
    buffer_load_dwordx4 v128, s[16:19], s58 offen offset:0 lds
    s_waitcnt lgkmcnt(2)
    v_mfma_f32_16x16x32_bf16 v[148:151], v[116:119], a[224:227], v[148:151]
    ds_read_b64_tr_b16 v[124:125], v29 offset:26624
    v_mfma_f32_16x16x32_bf16 v[156:159], v[116:119], a[228:231], v[156:159]
    ds_read_b64_tr_b16 v[126:127], v29 offset:27136
    v_mfma_f32_16x16x32_bf16 v[164:167], v[116:119], a[232:235], v[164:167]
    v_mfma_f32_16x16x32_bf16 v[172:175], v[116:119], a[236:239], v[172:175]
    buffer_load_dwordx4 v129, s[16:19], s58 offen offset:1024 lds
    s_waitcnt lgkmcnt(2)
    v_mfma_f32_16x16x32_bf16 v[144:147], v[120:123], a[240:243], v[144:147]
    v_mfma_f32_16x16x32_bf16 v[152:155], v[120:123], a[244:247], v[152:155]
    v_mfma_f32_16x16x32_bf16 v[160:163], v[120:123], a[248:251], v[160:163]
    v_mfma_f32_16x16x32_bf16 v[168:171], v[120:123], a[252:255], v[168:171]
    buffer_load_dwordx4 v130, s[16:19], s58 offen offset:2048 lds
    s_waitcnt lgkmcnt(0)
    v_mfma_f32_16x16x32_bf16 v[148:151], v[124:127], a[240:243], v[148:151]
    v_mfma_f32_16x16x32_bf16 v[156:159], v[124:127], a[244:247], v[156:159]
    v_mfma_f32_16x16x32_bf16 v[164:167], v[124:127], a[248:251], v[164:167]
    v_mfma_f32_16x16x32_bf16 v[172:175], v[124:127], a[252:255], v[172:175]
    buffer_load_dwordx4 v131, s[16:19], s58 offen offset:3072 lds
    s_add_u32 s100, s100, 65536
    s_and_b32 s100, s100, 0x7ffff
    v_pk_mul_f32 v[244:245], v[144:145], s[50:51]
    v_pk_mul_f32 v[246:247], v[146:147], s[50:51]
    v_pk_mul_f32 v[248:249], v[148:149], s[50:51]
    v_pk_mul_f32 v[250:251], v[150:151], s[50:51]
    v_exp_f32_e64 v244, v244 clamp
    v_exp_f32_e64 v245, v245 clamp
    v_max_f32 v144, s52, v144
    v_max_f32 v145, s52, v145
    v_exp_f32_e64 v246, v246 clamp
    v_exp_f32_e64 v247, v247 clamp
    v_max_f32 v146, s52, v146
    v_max_f32 v147, s52, v147
    v_exp_f32_e64 v248, v248 clamp
    v_exp_f32_e64 v249, v249 clamp
    v_max_f32 v148, s52, v148
    v_max_f32 v149, s52, v149
    v_exp_f32_e64 v250, v250 clamp
    v_exp_f32_e64 v251, v251 clamp
    v_max_f32 v150, s52, v150
    v_max_f32 v151, s52, v151
    v_pk_add_f32 v[144:145], v[144:145], v[244:245]
    v_pk_add_f32 v[146:147], v[146:147], v[246:247]
    s_add_u32 m0, s45, 114688
    s_add_u32 s58, s60, s100
    buffer_load_dwordx4 v128, s[16:19], s58 offen offset:0 lds
    v_pk_add_f32 v[148:149], v[148:149], v[248:249]
    v_pk_add_f32 v[150:151], v[150:151], v[250:251]
    v_cvt_pk_bf16_f32 v48, v144, v145
    v_cvt_pk_bf16_f32 v49, v146, v147
    v_cvt_pk_bf16_f32 v50, v148, v149
    v_cvt_pk_bf16_f32 v51, v150, v151
    v_pk_mul_f32 v[244:245], v[152:153], s[50:51]
    v_pk_mul_f32 v[246:247], v[154:155], s[50:51]
    v_pk_mul_f32 v[248:249], v[156:157], s[50:51]
    v_pk_mul_f32 v[250:251], v[158:159], s[50:51]
    v_exp_f32_e64 v244, v244 clamp
    v_exp_f32_e64 v245, v245 clamp
    v_max_f32 v152, s52, v152
    v_max_f32 v153, s52, v153
    v_exp_f32_e64 v246, v246 clamp
    v_exp_f32_e64 v247, v247 clamp
    v_max_f32 v154, s52, v154
    v_max_f32 v155, s52, v155
    v_exp_f32_e64 v248, v248 clamp
    v_exp_f32_e64 v249, v249 clamp
    v_max_f32 v156, s52, v156
    v_max_f32 v157, s52, v157
    buffer_load_dwordx4 v129, s[16:19], s58 offen offset:1024 lds
    v_exp_f32_e64 v250, v250 clamp
    v_exp_f32_e64 v251, v251 clamp
    v_max_f32 v158, s52, v158
    v_max_f32 v159, s52, v159
    v_pk_add_f32 v[152:153], v[152:153], v[244:245]
    v_pk_add_f32 v[154:155], v[154:155], v[246:247]
    v_pk_add_f32 v[156:157], v[156:157], v[248:249]
    v_pk_add_f32 v[158:159], v[158:159], v[250:251]
    v_cvt_pk_bf16_f32 v52, v152, v153
    v_cvt_pk_bf16_f32 v53, v154, v155
    v_cvt_pk_bf16_f32 v54, v156, v157
    v_cvt_pk_bf16_f32 v55, v158, v159
    v_pk_mul_f32 v[244:245], v[160:161], s[50:51]
    v_pk_mul_f32 v[246:247], v[162:163], s[50:51]
    v_pk_mul_f32 v[248:249], v[164:165], s[50:51]
    v_pk_mul_f32 v[250:251], v[166:167], s[50:51]
    v_exp_f32_e64 v244, v244 clamp
    v_exp_f32_e64 v245, v245 clamp
    v_max_f32 v160, s52, v160
    v_max_f32 v161, s52, v161
    v_exp_f32_e64 v246, v246 clamp
    v_exp_f32_e64 v247, v247 clamp
    buffer_load_dwordx4 v130, s[16:19], s58 offen offset:2048 lds
    v_max_f32 v162, s52, v162
    v_max_f32 v163, s52, v163
    v_exp_f32_e64 v248, v248 clamp
    v_exp_f32_e64 v249, v249 clamp
    v_max_f32 v164, s52, v164
    v_max_f32 v165, s52, v165
    v_exp_f32_e64 v250, v250 clamp
    v_exp_f32_e64 v251, v251 clamp
    v_max_f32 v166, s52, v166
    v_max_f32 v167, s52, v167
    v_pk_add_f32 v[160:161], v[160:161], v[244:245]
    v_pk_add_f32 v[162:163], v[162:163], v[246:247]
    v_pk_add_f32 v[164:165], v[164:165], v[248:249]
    v_pk_add_f32 v[166:167], v[166:167], v[250:251]
    v_cvt_pk_bf16_f32 v56, v160, v161
    v_cvt_pk_bf16_f32 v57, v162, v163
    v_cvt_pk_bf16_f32 v58, v164, v165
    v_cvt_pk_bf16_f32 v59, v166, v167
    v_pk_mul_f32 v[244:245], v[168:169], s[50:51]
    v_pk_mul_f32 v[246:247], v[170:171], s[50:51]
    v_pk_mul_f32 v[248:249], v[172:173], s[50:51]
    v_pk_mul_f32 v[250:251], v[174:175], s[50:51]
    buffer_load_dwordx4 v131, s[16:19], s58 offen offset:3072 lds
    s_add_u32 s100, s100, 65536
    s_and_b32 s100, s100, 0x7ffff
    v_exp_f32_e64 v244, v244 clamp
    v_exp_f32_e64 v245, v245 clamp
    v_max_f32 v168, s52, v168
    v_max_f32 v169, s52, v169
    v_exp_f32_e64 v246, v246 clamp
    v_exp_f32_e64 v247, v247 clamp
    v_max_f32 v170, s52, v170
    v_max_f32 v171, s52, v171
    v_exp_f32_e64 v248, v248 clamp
    v_exp_f32_e64 v249, v249 clamp
    v_max_f32 v172, s52, v172
    v_max_f32 v173, s52, v173
    v_exp_f32_e64 v250, v250 clamp
    v_exp_f32_e64 v251, v251 clamp
    v_max_f32 v174, s52, v174
    v_max_f32 v175, s52, v175
    v_pk_add_f32 v[168:169], v[168:169], v[244:245]
    v_pk_add_f32 v[170:171], v[170:171], v[246:247]
    v_pk_add_f32 v[172:173], v[172:173], v[248:249]
    v_pk_add_f32 v[174:175], v[174:175], v[250:251]
    v_cvt_pk_bf16_f32 v60, v168, v169
    v_cvt_pk_bf16_f32 v61, v170, v171
    v_cvt_pk_bf16_f32 v62, v172, v173
    v_cvt_pk_bf16_f32 v63, v174, v175
    s_waitcnt vmcnt(18)
    v_max3_u32 v18, v208, v209, v210
    v_max_u32 v18, v18, v211
    v_cmp_eq_u32 vcc, -1, v18
    s_cbranch_vccnz L_zslow8
L_zok9:
    s_waitcnt vmcnt(10)
    v_mfma_f32_16x16x32_bf16 v[224:227], v[134:137], v[176:179], 0
    v_add_f32_dpp v208, v208, v208 row_ror:8 row_mask:0xf bank_mask:0xf
    v_mfma_f32_16x16x32_bf16 v[228:231], v[132:135], v[176:179], 0
    v_add_f32_dpp v209, v209, v209 row_ror:8 row_mask:0xf bank_mask:0xf
    v_mfma_f32_16x16x32_bf16 v[224:227], v[134:137], v[180:183], v[224:227]
    v_add_f32_dpp v210, v210, v210 row_ror:8 row_mask:0xf bank_mask:0xf
    v_mfma_f32_16x16x32_bf16 v[228:231], v[132:135], v[180:183], v[228:231]
    v_add_f32_dpp v211, v211, v211 row_ror:8 row_mask:0xf bank_mask:0xf
    v_mfma_f32_16x16x32_bf16 v[224:227], v[134:137], v[184:187], v[224:227]
    v_add_f32_dpp v208, v208, v208 row_ror:4 row_mask:0xf bank_mask:0xf
    v_mfma_f32_16x16x32_bf16 v[228:231], v[132:135], v[184:187], v[228:231]
    v_add_f32_dpp v209, v209, v209 row_ror:4 row_mask:0xf bank_mask:0xf
    v_mfma_f32_16x16x32_bf16 v[224:227], v[134:137], v[188:191], v[224:227]
    v_add_f32_dpp v210, v210, v210 row_ror:4 row_mask:0xf bank_mask:0xf
    v_mfma_f32_16x16x32_bf16 v[228:231], v[132:135], v[188:191], v[228:231]
    v_add_f32_dpp v211, v211, v211 row_ror:4 row_mask:0xf bank_mask:0xf
    v_mfma_f32_16x16x32_bf16 v[224:227], v[134:137], v[192:195], v[224:227]
    v_add_f32_dpp v208, v208, v208 row_ror:2 row_mask:0xf bank_mask:0xf
    v_mfma_f32_16x16x32_bf16 v[228:231], v[132:135], v[192:195], v[228:231]
    v_add_f32_dpp v209, v209, v209 row_ror:2 row_mask:0xf bank_mask:0xf
    v_mfma_f32_16x16x32_bf16 v[224:227], v[134:137], v[196:199], v[224:227]
    v_add_f32_dpp v210, v210, v210 row_ror:2 row_mask:0xf bank_mask:0xf
    v_add_f32_dpp v211, v211, v211 row_ror:2 row_mask:0xf bank_mask:0xf
    v_mfma_f32_16x16x32_bf16 v[228:231], v[132:135], v[196:199], v[228:231]
    v_add_f32_dpp v208, v208, v208 row_ror:1 row_mask:0xf bank_mask:0xf
    v_add_f32_dpp v209, v209, v209 row_ror:1 row_mask:0xf bank_mask:0xf
    v_mfma_f32_16x16x32_bf16 v[224:227], v[134:137], v[200:203], v[224:227]
    v_add_f32_dpp v210, v210, v210 row_ror:1 row_mask:0xf bank_mask:0xf
    v_add_f32_dpp v211, v211, v211 row_ror:1 row_mask:0xf bank_mask:0xf
    v_mfma_f32_16x16x32_bf16 v[228:231], v[132:135], v[200:203], v[228:231]
    v_cvt_pk_bf16_f32 v18, v208, v209
    v_cvt_pk_bf16_f32 v19, v210, v211
    v_mfma_f32_16x16x32_bf16 v[224:227], v[134:137], v[204:207], v[224:227]
    v_cndmask_b32_e64 v18, 0, v18, s[48:49]
    v_cndmask_b32_e64 v19, 0, v19, s[48:49]
    v_mfma_f32_16x16x32_bf16 v[228:231], v[132:135], v[204:207], v[228:231]
    ds_write_b64 v31, v[18:19]
    s_nop 3
    v_cmp_u_f32 vcc, v224, v224
    s_cbranch_vccnz L_gslow10
L_gok11:
    ds_write_b128 v140, v[224:227] offset:0
    ds_write_b128 v140, v[228:231] offset:1024
    s_waitcnt lgkmcnt(0)
    s_barrier
    ds_read2st64_b64 v[212:215], v32 offset0:0 offset1:2
    ds_read_b128 v[232:235], v141 offset:0
    ds_read_b128 v[236:239], v141 offset:1024
    s_add_u32 m0, s45, 131072
    s_add_u32 s58, s60, s100
    buffer_load_dwordx4 v128, s[16:19], s58 offen offset:0 lds
    buffer_load_dwordx4 v129, s[16:19], s58 offen offset:1024 lds
    buffer_load_dwordx4 v130, s[16:19], s58 offen offset:2048 lds
    buffer_load_dwordx4 v131, s[16:19], s58 offen offset:3072 lds
    buffer_load_dwordx2 v[40:41], v0, s[20:23], 0 offen sc1
    s_waitcnt lgkmcnt(1)
    v_pk_add_f32 v[224:225], v[224:225], v[232:233]
    v_pk_add_f32 v[226:227], v[226:227], v[234:235]
    s_waitcnt lgkmcnt(0)
    v_pk_add_f32 v[228:229], v[228:229], v[236:237]
    v_pk_add_f32 v[230:231], v[230:231], v[238:239]
    v_mfma_f32_16x16x32_bf16 v[64:67], v[212:215], v[48:51], 0
    v_cvt_pk_bf16_f32 v216, v224, v225
    v_mfma_f32_16x16x32_bf16 v[68:71], v[212:215], v[52:55], 0
    v_cvt_pk_bf16_f32 v217, v226, v227
    v_mfma_f32_16x16x32_bf16 v[72:75], v[212:215], v[56:59], 0
    v_cvt_pk_bf16_f32 v220, v228, v229
    v_mfma_f32_16x16x32_bf16 v[76:79], v[212:215], v[60:63], 0
    v_cvt_pk_bf16_f32 v221, v230, v231
    v_mfma_f32_16x16x32_bf16 v[144:147], v[216:219], v[48:51], 0
    s_nop 0
    v_mfma_f32_16x16x32_bf16 v[148:151], v[218:221], v[48:51], 0
    v_add_f32 v64, s52, v64
    v_rcp_f32 v64, v64
    v_mfma_f32_16x16x32_bf16 v[152:155], v[216:219], v[52:55], 0
    v_add_f32 v65, s52, v65
    v_rcp_f32 v65, v65
    v_mfma_f32_16x16x32_bf16 v[156:159], v[218:221], v[52:55], 0
    v_add_f32 v68, s52, v68
    v_rcp_f32 v68, v68
    v_mfma_f32_16x16x32_bf16 v[160:163], v[216:219], v[56:59], 0
    v_add_f32 v69, s52, v69
    v_rcp_f32 v69, v69
    v_mfma_f32_16x16x32_bf16 v[164:167], v[218:221], v[56:59], 0
    v_add_f32 v72, s52, v72
    v_rcp_f32 v72, v72
    v_mfma_f32_16x16x32_bf16 v[168:171], v[216:219], v[60:63], 0
    v_add_f32 v73, s52, v73
    v_rcp_f32 v73, v73
    v_mfma_f32_16x16x32_bf16 v[172:175], v[218:221], v[60:63], 0
    v_add_f32 v76, s52, v76
    v_rcp_f32 v76, v76
    v_add_f32 v77, s52, v77
    v_rcp_f32 v77, v77
    v_pk_mul_f32 v[144:145], v[144:145], v[64:65] op_sel:[0,0] op_sel_hi:[1,0]
    v_pk_mul_f32 v[146:147], v[146:147], v[64:65] op_sel:[0,0] op_sel_hi:[1,0]
    v_pk_mul_f32 v[148:149], v[148:149], v[64:65] op_sel:[0,1] op_sel_hi:[1,1]
    v_pk_mul_f32 v[150:151], v[150:151], v[64:65] op_sel:[0,1] op_sel_hi:[1,1]
    v_cvt_pk_bf16_f32 v64, v144, v145
    v_cvt_pk_bf16_f32 v65, v146, v147
    v_cvt_pk_bf16_f32 v66, v148, v149
    v_cvt_pk_bf16_f32 v67, v150, v151
    buffer_store_dwordx4 v[64:67], v16, s[20:23], s55 offen offset:0 sc1
    v_pk_mul_f32 v[152:153], v[152:153], v[68:69] op_sel:[0,0] op_sel_hi:[1,0]
    v_pk_mul_f32 v[154:155], v[154:155], v[68:69] op_sel:[0,0] op_sel_hi:[1,0]
    v_pk_mul_f32 v[156:157], v[156:157], v[68:69] op_sel:[0,1] op_sel_hi:[1,1]
    v_pk_mul_f32 v[158:159], v[158:159], v[68:69] op_sel:[0,1] op_sel_hi:[1,1]
    v_cvt_pk_bf16_f32 v68, v152, v153
    v_cvt_pk_bf16_f32 v69, v154, v155
    v_cvt_pk_bf16_f32 v70, v156, v157
    v_cvt_pk_bf16_f32 v71, v158, v159
    buffer_store_dwordx4 v[68:71], v16, s[20:23], s55 offen offset:1024 sc1
    v_pk_mul_f32 v[160:161], v[160:161], v[72:73] op_sel:[0,0] op_sel_hi:[1,0]
    v_pk_mul_f32 v[162:163], v[162:163], v[72:73] op_sel:[0,0] op_sel_hi:[1,0]
    v_pk_mul_f32 v[164:165], v[164:165], v[72:73] op_sel:[0,1] op_sel_hi:[1,1]
    v_pk_mul_f32 v[166:167], v[166:167], v[72:73] op_sel:[0,1] op_sel_hi:[1,1]
    v_cvt_pk_bf16_f32 v72, v160, v161
    v_cvt_pk_bf16_f32 v73, v162, v163
    v_cvt_pk_bf16_f32 v74, v164, v165
    v_cvt_pk_bf16_f32 v75, v166, v167
    buffer_store_dwordx4 v[72:75], v16, s[20:23], s61 offen offset:0 sc1
    v_pk_mul_f32 v[168:169], v[168:169], v[76:77] op_sel:[0,0] op_sel_hi:[1,0]
    v_pk_mul_f32 v[170:171], v[170:171], v[76:77] op_sel:[0,0] op_sel_hi:[1,0]
    v_pk_mul_f32 v[172:173], v[172:173], v[76:77] op_sel:[0,1] op_sel_hi:[1,1]
    v_pk_mul_f32 v[174:175], v[174:175], v[76:77] op_sel:[0,1] op_sel_hi:[1,1]
    v_cvt_pk_bf16_f32 v76, v168, v169
    v_cvt_pk_bf16_f32 v77, v170, v171
    v_cvt_pk_bf16_f32 v78, v172, v173
    v_cvt_pk_bf16_f32 v79, v174, v175
    buffer_store_dwordx4 v[76:79], v16, s[20:23], s61 offen offset:1024 sc1
    s_waitcnt vmcnt(4)
    v_cmp_ne_u64 vcc, v[4:5], v[40:41]
    s_cbranch_vccnz L_hs12
L_ho13:
    buffer_load_dword v42, v46, s[20:23], s65 offen sc1
    buffer_load_dword v44, v46, s[20:23], s65 offen offset:1024 sc1
    s_barrier
    v_pk_mov_b32 v[208:209], 0, 0
    v_pk_mov_b32 v[210:211], 0, 0
    v_pk_mov_b32 v[212:213], 0, 0
    v_pk_mov_b32 v[214:215], 0, 0
    v_pk_mov_b32 v[216:217], 0, 0
    v_pk_mov_b32 v[218:219], 0, 0
    v_pk_mov_b32 v[220:221], 0, 0
    v_pk_mov_b32 v[222:223], 0, 0
    v_pk_mov_b32 v[224:225], 0, 0
    v_pk_mov_b32 v[226:227], 0, 0
    v_pk_mov_b32 v[228:229], 0, 0
    v_pk_mov_b32 v[230:231], 0, 0
    v_pk_mov_b32 v[232:233], 0, 0
    v_pk_mov_b32 v[234:235], 0, 0
    v_pk_mov_b32 v[236:237], 0, 0
    v_pk_mov_b32 v[238:239], 0, 0
    s_mov_b32 s99, 0
    v_xor_b32 v47, 8192, v139
    ds_read_b64_tr_b16 a[0:1], v100 offset:16384
    ds_read_b64_tr_b16 a[2:3], v100 offset:17408
    ds_read_b64_tr_b16 a[4:5], v103 offset:16384
    ds_read_b64_tr_b16 a[6:7], v103 offset:17408
    ds_read_b64_tr_b16 a[8:9], v106 offset:16384
    ds_read_b64_tr_b16 a[10:11], v106 offset:17408
    ds_read_b64_tr_b16 a[12:13], v109 offset:16384
    ds_read_b64_tr_b16 a[14:15], v109 offset:17408
    ds_read_b64_tr_b16 a[16:17], v100 offset:18432
    ds_read_b64_tr_b16 a[18:19], v100 offset:19456
    ds_read_b64_tr_b16 a[20:21], v103 offset:18432
    ds_read_b64_tr_b16 a[22:23], v103 offset:19456
    ds_read_b64_tr_b16 a[24:25], v106 offset:18432
    ds_read_b64_tr_b16 a[26:27], v106 offset:19456
    ds_read_b64_tr_b16 a[28:29], v109 offset:18432
    ds_read_b64_tr_b16 a[30:31], v109 offset:19456
    ds_read_b64_tr_b16 a[32:33], v100 offset:32768
    ds_read_b64_tr_b16 a[34:35], v100 offset:33792
    ds_read_b64_tr_b16 a[36:37], v103 offset:32768
    ds_read_b64_tr_b16 a[38:39], v103 offset:33792
    ds_read_b64_tr_b16 a[40:41], v106 offset:32768
    ds_read_b64_tr_b16 a[42:43], v106 offset:33792
    ds_read_b64_tr_b16 a[44:45], v109 offset:32768
    ds_read_b64_tr_b16 a[46:47], v109 offset:33792
    ds_read_b64_tr_b16 a[48:49], v100 offset:34816
    ds_read_b64_tr_b16 a[50:51], v100 offset:35840
    ds_read_b64_tr_b16 a[52:53], v103 offset:34816
    ds_read_b64_tr_b16 a[54:55], v103 offset:35840
    ds_read_b64_tr_b16 a[56:57], v106 offset:34816
    ds_read_b64_tr_b16 a[58:59], v106 offset:35840
    ds_read_b64_tr_b16 a[60:61], v109 offset:34816
    ds_read_b64_tr_b16 a[62:63], v109 offset:35840
    ds_read_b64_tr_b16 a[64:65], v100 offset:49152
    ds_read_b64_tr_b16 a[66:67], v100 offset:50176
    ds_read_b64_tr_b16 a[68:69], v103 offset:49152
    ds_read_b64_tr_b16 a[70:71], v103 offset:50176
    ds_read_b64_tr_b16 a[72:73], v106 offset:49152
    ds_read_b64_tr_b16 a[74:75], v106 offset:50176
    ds_read_b64_tr_b16 a[76:77], v109 offset:49152
    ds_read_b64_tr_b16 a[78:79], v109 offset:50176
    ds_read_b64_tr_b16 a[80:81], v100 offset:51200
    ds_read_b64_tr_b16 a[82:83], v100 offset:52224
    ds_read_b64_tr_b16 a[84:85], v103 offset:51200
    ds_read_b64_tr_b16 a[86:87], v103 offset:52224
    ds_read_b64_tr_b16 a[88:89], v106 offset:51200
    ds_read_b64_tr_b16 a[90:91], v106 offset:52224
    ds_read_b64_tr_b16 a[92:93], v109 offset:51200
    ds_read_b64_tr_b16 a[94:95], v109 offset:52224
    ds_read_b64_tr_b16 a[96:97], v101 offset:0
    ds_read_b64_tr_b16 a[98:99], v101 offset:1024
    ds_read_b64_tr_b16 a[100:101], v104 offset:0
    ds_read_b64_tr_b16 a[102:103], v104 offset:1024
    ds_read_b64_tr_b16 a[104:105], v107 offset:0
    ds_read_b64_tr_b16 a[106:107], v107 offset:1024
    ds_read_b64_tr_b16 a[108:109], v110 offset:0
    ds_read_b64_tr_b16 a[110:111], v110 offset:1024
    ds_read_b64_tr_b16 a[112:113], v101 offset:2048
    ds_read_b64_tr_b16 a[114:115], v101 offset:3072
    ds_read_b64_tr_b16 a[116:117], v104 offset:2048
    ds_read_b64_tr_b16 a[118:119], v104 offset:3072
    ds_read_b64_tr_b16 a[120:121], v107 offset:2048
    ds_read_b64_tr_b16 a[122:123], v107 offset:3072
    ds_read_b64_tr_b16 a[124:125], v110 offset:2048
    ds_read_b64_tr_b16 a[126:127], v110 offset:3072
    ds_read_b64_tr_b16 a[128:129], v101 offset:16384
    ds_read_b64_tr_b16 a[130:131], v101 offset:17408
    ds_read_b64_tr_b16 a[132:133], v104 offset:16384
    ds_read_b64_tr_b16 a[134:135], v104 offset:17408
    s_waitcnt vmcnt(2)
    s_add_u32 s57, s101, 0
    s_and_b32 s57, s57, 0x7fff
    s_add_u32 s57, s57, s64
    buffer_load_dwordx4 v[48:51], v16, s[20:23], s57 offen offset:0 sc1
    ds_read_b64_tr_b16 a[136:137], v107 offset:16384
    ds_read_b64_tr_b16 a[138:139], v107 offset:17408
    ds_read_b64_tr_b16 a[140:141], v110 offset:16384
    ds_read_b64_tr_b16 a[142:143], v110 offset:17408
    ds_read_b64_tr_b16 a[144:145], v101 offset:18432
    buffer_load_dwordx4 v[52:55], v16, s[20:23], s57 offen offset:1024 sc1
    ds_read_b64_tr_b16 a[146:147], v101 offset:19456
    ds_read_b64_tr_b16 a[148:149], v104 offset:18432
    ds_read_b64_tr_b16 a[150:151], v104 offset:19456
    ds_read_b64_tr_b16 a[152:153], v107 offset:18432
    ds_read_b64_tr_b16 a[154:155], v107 offset:19456
    buffer_load_dwordx4 v[56:59], v16, s[20:23], s57 offen offset:2048 sc1
    ds_read_b64_tr_b16 a[156:157], v110 offset:18432
    ds_read_b64_tr_b16 a[158:159], v110 offset:19456
    ds_read_b64_tr_b16 a[160:161], v101 offset:32768
    ds_read_b64_tr_b16 a[162:163], v101 offset:33792
    ds_read_b64_tr_b16 a[164:165], v104 offset:32768
    buffer_load_dwordx4 v[60:63], v16, s[20:23], s57 offen offset:3072 sc1
    ds_read_b64_tr_b16 a[166:167], v104 offset:33792
    ds_read_b64_tr_b16 a[168:169], v107 offset:32768
    ds_read_b64_tr_b16 a[170:171], v107 offset:33792
    ds_read_b64_tr_b16 a[172:173], v110 offset:32768
    ds_read_b64_tr_b16 a[174:175], v110 offset:33792
    s_add_u32 s57, s101, 4096
    s_and_b32 s57, s57, 0x7fff
    s_add_u32 s57, s57, s64
    buffer_load_dwordx4 v[64:67], v16, s[20:23], s57 offen offset:0 sc1
    ds_read_b64_tr_b16 a[176:177], v101 offset:34816
    ds_read_b64_tr_b16 a[178:179], v101 offset:35840
    ds_read_b64_tr_b16 a[180:181], v104 offset:34816
    ds_read_b64_tr_b16 a[182:183], v104 offset:35840
    ds_read_b64_tr_b16 a[184:185], v107 offset:34816
    buffer_load_dwordx4 v[68:71], v16, s[20:23], s57 offen offset:1024 sc1
    ds_read_b64_tr_b16 a[186:187], v107 offset:35840
    ds_read_b64_tr_b16 a[188:189], v110 offset:34816
    ds_read_b64_tr_b16 a[190:191], v110 offset:35840
    ds_read_b64_tr_b16 a[192:193], v101 offset:49152
    ds_read_b64_tr_b16 a[194:195], v101 offset:50176
    buffer_load_dwordx4 v[72:75], v16, s[20:23], s57 offen offset:2048 sc1
    ds_read_b64_tr_b16 a[196:197], v104 offset:49152
    ds_read_b64_tr_b16 a[198:199], v104 offset:50176
    ds_read_b64_tr_b16 a[200:201], v107 offset:49152
    ds_read_b64_tr_b16 a[202:203], v107 offset:50176
    ds_read_b64_tr_b16 a[204:205], v110 offset:49152
    buffer_load_dwordx4 v[76:79], v16, s[20:23], s57 offen offset:3072 sc1
    ds_read_b64_tr_b16 a[206:207], v110 offset:50176
    ds_read_b64_tr_b16 a[208:209], v101 offset:51200
    ds_read_b64_tr_b16 a[210:211], v101 offset:52224
    ds_read_b64_tr_b16 a[212:213], v104 offset:51200
    ds_read_b64_tr_b16 a[214:215], v104 offset:52224
    s_add_u32 s57, s101, 8192
    s_and_b32 s57, s57, 0x7fff
    s_add_u32 s57, s57, s64
    buffer_load_dwordx4 v[80:83], v16, s[20:23], s57 offen offset:0 sc1
    ds_read_b64_tr_b16 a[216:217], v107 offset:51200
    ds_read_b64_tr_b16 a[218:219], v107 offset:52224
    ds_read_b64_tr_b16 a[220:221], v110 offset:51200
    ds_read_b64_tr_b16 a[222:223], v110 offset:52224
    ds_read_b64_tr_b16 a[224:225], v102 offset:0
    buffer_load_dwordx4 v[84:87], v16, s[20:23], s57 offen offset:1024 sc1
    ds_read_b64_tr_b16 a[226:227], v102 offset:1024
    ds_read_b64_tr_b16 a[228:229], v105 offset:0
    ds_read_b64_tr_b16 a[230:231], v105 offset:1024
    ds_read_b64_tr_b16 a[232:233], v108 offset:0
    ds_read_b64_tr_b16 a[234:235], v108 offset:1024
    buffer_load_dwordx4 v[88:91], v16, s[20:23], s57 offen offset:2048 sc1
    ds_read_b64_tr_b16 a[236:237], v111 offset:0
    ds_read_b64_tr_b16 a[238:239], v111 offset:1024
    ds_read_b64_tr_b16 a[240:241], v102 offset:2048
    ds_read_b64_tr_b16 a[242:243], v102 offset:3072
    ds_read_b64_tr_b16 a[244:245], v105 offset:2048
    buffer_load_dwordx4 v[92:95], v16, s[20:23], s57 offen offset:3072 sc1
    ds_read_b64_tr_b16 a[246:247], v105 offset:3072
    ds_read_b64_tr_b16 a[248:249], v108 offset:2048
    ds_read_b64_tr_b16 a[250:251], v108 offset:3072
    ds_read_b64_tr_b16 a[252:253], v111 offset:2048
    ds_read_b64_tr_b16 a[254:255], v111 offset:3072
    s_waitcnt lgkmcnt(0)
    s_waitcnt vmcnt(11)
    v_max3_u32 v244, v48, v49, v50
    s_waitcnt vmcnt(10)
    v_max3_u32 v244, v244, v51, v52
    v_max3_u32 v244, v244, v53, v54
    s_waitcnt vmcnt(9)
    v_max3_u32 v244, v244, v55, v56
    v_max3_u32 v244, v244, v57, v58
    s_waitcnt vmcnt(8)
    v_max3_u32 v244, v244, v59, v60
    v_max3_u32 v244, v244, v61, v62
    v_max_u32 v244, v244, v63
    v_cmp_eq_u32 vcc, -1, v244
    s_cbranch_vccnz L_osk14
    v_mfma_f32_16x16x32_bf16 v[208:211], a[0:3], v[48:51], v[208:211]
    s_add_u32 s57, s101, 12288
    s_and_b32 s57, s57, 0x7fff
    v_mfma_f32_16x16x32_bf16 v[216:219], a[4:7], v[48:51], v[216:219]
    s_add_u32 s57, s57, s64
    buffer_load_dwordx4 v[112:115], v16, s[20:23], s57 offen offset:0 sc1
    v_mfma_f32_16x16x32_bf16 v[224:227], a[8:11], v[48:51], v[224:227]
    v_mfma_f32_16x16x32_bf16 v[232:235], a[12:15], v[48:51], v[232:235]
    v_mfma_f32_16x16x32_bf16 v[212:215], a[0:3], v[52:55], v[212:215]
    v_mfma_f32_16x16x32_bf16 v[220:223], a[4:7], v[52:55], v[220:223]
    buffer_load_dwordx4 v[116:119], v16, s[20:23], s57 offen offset:1024 sc1
    v_mfma_f32_16x16x32_bf16 v[228:231], a[8:11], v[52:55], v[228:231]
    v_mfma_f32_16x16x32_bf16 v[236:239], a[12:15], v[52:55], v[236:239]
    v_mfma_f32_16x16x32_bf16 v[208:211], a[16:19], v[56:59], v[208:211]
    v_mfma_f32_16x16x32_bf16 v[216:219], a[20:23], v[56:59], v[216:219]
    buffer_load_dwordx4 v[120:123], v16, s[20:23], s57 offen offset:2048 sc1
    v_mfma_f32_16x16x32_bf16 v[224:227], a[24:27], v[56:59], v[224:227]
    s_waitcnt vmcnt(7)
    v_max3_u32 v244, v64, v65, v66
    v_max3_u32 v244, v244, v67, v68
    v_mfma_f32_16x16x32_bf16 v[232:235], a[28:31], v[56:59], v[232:235]
    v_max3_u32 v244, v244, v69, v70
    v_max3_u32 v244, v244, v71, v72
    v_mfma_f32_16x16x32_bf16 v[212:215], a[16:19], v[60:63], v[212:215]
    v_max3_u32 v244, v244, v73, v74
    v_max3_u32 v244, v244, v75, v76
    v_mfma_f32_16x16x32_bf16 v[220:223], a[20:23], v[60:63], v[220:223]
    buffer_load_dwordx4 v[124:127], v16, s[20:23], s57 offen offset:3072 sc1
    v_mfma_f32_16x16x32_bf16 v[228:231], a[24:27], v[60:63], v[228:231]
    v_max3_u32 v244, v244, v77, v78
    v_max_u32 v244, v244, v79
    v_cmp_eq_u32 vcc, -1, v244
    v_mfma_f32_16x16x32_bf16 v[236:239], a[28:31], v[60:63], v[236:239]
L_onx15:
    s_cbranch_vccnz L_osk16
    v_mfma_f32_16x16x32_bf16 v[208:211], a[32:35], v[64:67], v[208:211]
    s_add_u32 s57, s101, 16384
    s_and_b32 s57, s57, 0x7fff
    v_mfma_f32_16x16x32_bf16 v[216:219], a[36:39], v[64:67], v[216:219]
    s_add_u32 s57, s57, s64
    buffer_load_dwordx4 v[144:147], v16, s[20:23], s57 offen offset:0 sc1
    v_mfma_f32_16x16x32_bf16 v[224:227], a[40:43], v[64:67], v[224:227]
    v_mfma_f32_16x16x32_bf16 v[232:235], a[44:47], v[64:67], v[232:235]
    v_mfma_f32_16x16x32_bf16 v[212:215], a[32:35], v[68:71], v[212:215]
    v_mfma_f32_16x16x32_bf16 v[220:223], a[36:39], v[68:71], v[220:223]
    buffer_load_dwordx4 v[148:151], v16, s[20:23], s57 offen offset:1024 sc1
    v_mfma_f32_16x16x32_bf16 v[228:231], a[40:43], v[68:71], v[228:231]
    v_mfma_f32_16x16x32_bf16 v[236:239], a[44:47], v[68:71], v[236:239]
    v_mfma_f32_16x16x32_bf16 v[208:211], a[48:51], v[72:75], v[208:211]
    v_mfma_f32_16x16x32_bf16 v[216:219], a[52:55], v[72:75], v[216:219]
    buffer_load_dwordx4 v[152:155], v16, s[20:23], s57 offen offset:2048 sc1
    v_mfma_f32_16x16x32_bf16 v[224:227], a[56:59], v[72:75], v[224:227]
    s_waitcnt vmcnt(7)
    v_max3_u32 v244, v80, v81, v82
    v_max3_u32 v244, v244, v83, v84
    v_mfma_f32_16x16x32_bf16 v[232:235], a[60:63], v[72:75], v[232:235]
    v_max3_u32 v244, v244, v85, v86
    v_max3_u32 v244, v244, v87, v88
    v_mfma_f32_16x16x32_bf16 v[212:215], a[48:51], v[76:79], v[212:215]
    v_max3_u32 v244, v244, v89, v90
    v_max3_u32 v244, v244, v91, v92
    v_mfma_f32_16x16x32_bf16 v[220:223], a[52:55], v[76:79], v[220:223]
    buffer_load_dwordx4 v[156:159], v16, s[20:23], s57 offen offset:3072 sc1
    v_mfma_f32_16x16x32_bf16 v[228:231], a[56:59], v[76:79], v[228:231]
    v_max3_u32 v244, v244, v93, v94
    v_max_u32 v244, v244, v95
    v_cmp_eq_u32 vcc, -1, v244
    v_mfma_f32_16x16x32_bf16 v[236:239], a[60:63], v[76:79], v[236:239]
L_onx17:
    s_cbranch_vccnz L_osk18
    v_mfma_f32_16x16x32_bf16 v[208:211], a[64:67], v[80:83], v[208:211]
    s_add_u32 s57, s101, 20480
    s_and_b32 s57, s57, 0x7fff
    v_mfma_f32_16x16x32_bf16 v[216:219], a[68:71], v[80:83], v[216:219]
    s_add_u32 s57, s57, s64
    buffer_load_dwordx4 v[160:163], v16, s[20:23], s57 offen offset:0 sc1
    v_mfma_f32_16x16x32_bf16 v[224:227], a[72:75], v[80:83], v[224:227]
    v_mfma_f32_16x16x32_bf16 v[232:235], a[76:79], v[80:83], v[232:235]
    v_mfma_f32_16x16x32_bf16 v[212:215], a[64:67], v[84:87], v[212:215]
    v_mfma_f32_16x16x32_bf16 v[220:223], a[68:71], v[84:87], v[220:223]
    buffer_load_dwordx4 v[164:167], v16, s[20:23], s57 offen offset:1024 sc1
    v_mfma_f32_16x16x32_bf16 v[228:231], a[72:75], v[84:87], v[228:231]
    v_mfma_f32_16x16x32_bf16 v[236:239], a[76:79], v[84:87], v[236:239]
    v_mfma_f32_16x16x32_bf16 v[208:211], a[80:83], v[88:91], v[208:211]
    v_mfma_f32_16x16x32_bf16 v[216:219], a[84:87], v[88:91], v[216:219]
    buffer_load_dwordx4 v[168:171], v16, s[20:23], s57 offen offset:2048 sc1
    v_mfma_f32_16x16x32_bf16 v[224:227], a[88:91], v[88:91], v[224:227]
    s_waitcnt vmcnt(7)
    v_max3_u32 v244, v112, v113, v114
    v_max3_u32 v244, v244, v115, v116
    v_mfma_f32_16x16x32_bf16 v[232:235], a[92:95], v[88:91], v[232:235]
    v_max3_u32 v244, v244, v117, v118
    v_max3_u32 v244, v244, v119, v120
    v_mfma_f32_16x16x32_bf16 v[212:215], a[80:83], v[92:95], v[212:215]
    v_max3_u32 v244, v244, v121, v122
    v_max3_u32 v244, v244, v123, v124
    v_mfma_f32_16x16x32_bf16 v[220:223], a[84:87], v[92:95], v[220:223]
    buffer_load_dwordx4 v[172:175], v16, s[20:23], s57 offen offset:3072 sc1
    v_mfma_f32_16x16x32_bf16 v[228:231], a[88:91], v[92:95], v[228:231]
    v_max3_u32 v244, v244, v125, v126
    v_max_u32 v244, v244, v127
    v_cmp_eq_u32 vcc, -1, v244
    v_mfma_f32_16x16x32_bf16 v[236:239], a[92:95], v[92:95], v[236:239]
L_onx19:
    s_cbranch_vccnz L_osk20
    v_mfma_f32_16x16x32_bf16 v[208:211], a[96:99], v[112:115], v[208:211]
    s_add_u32 s57, s101, 24576
    s_and_b32 s57, s57, 0x7fff
    v_mfma_f32_16x16x32_bf16 v[216:219], a[100:103], v[112:115], v[216:219]
    s_add_u32 s57, s57, s64
    buffer_load_dwordx4 v[176:179], v16, s[20:23], s57 offen offset:0 sc1
    v_mfma_f32_16x16x32_bf16 v[224:227], a[104:107], v[112:115], v[224:227]
    v_mfma_f32_16x16x32_bf16 v[232:235], a[108:111], v[112:115], v[232:235]
    v_mfma_f32_16x16x32_bf16 v[212:215], a[96:99], v[116:119], v[212:215]
    v_mfma_f32_16x16x32_bf16 v[220:223], a[100:103], v[116:119], v[220:223]
    buffer_load_dwordx4 v[180:183], v16, s[20:23], s57 offen offset:1024 sc1
    v_mfma_f32_16x16x32_bf16 v[228:231], a[104:107], v[116:119], v[228:231]
    v_mfma_f32_16x16x32_bf16 v[236:239], a[108:111], v[116:119], v[236:239]
    v_mfma_f32_16x16x32_bf16 v[208:211], a[112:115], v[120:123], v[208:211]
    v_mfma_f32_16x16x32_bf16 v[216:219], a[116:119], v[120:123], v[216:219]
    buffer_load_dwordx4 v[184:187], v16, s[20:23], s57 offen offset:2048 sc1
    v_mfma_f32_16x16x32_bf16 v[224:227], a[120:123], v[120:123], v[224:227]
    s_waitcnt vmcnt(7)
    v_max3_u32 v244, v144, v145, v146
    v_max3_u32 v244, v244, v147, v148
    v_mfma_f32_16x16x32_bf16 v[232:235], a[124:127], v[120:123], v[232:235]
    v_max3_u32 v244, v244, v149, v150
    v_max3_u32 v244, v244, v151, v152
    v_mfma_f32_16x16x32_bf16 v[212:215], a[112:115], v[124:127], v[212:215]
    v_max3_u32 v244, v244, v153, v154
    v_max3_u32 v244, v244, v155, v156
    v_mfma_f32_16x16x32_bf16 v[220:223], a[116:119], v[124:127], v[220:223]
    buffer_load_dwordx4 v[188:191], v16, s[20:23], s57 offen offset:3072 sc1
    v_mfma_f32_16x16x32_bf16 v[228:231], a[120:123], v[124:127], v[228:231]
    v_max3_u32 v244, v244, v157, v158
    v_max_u32 v244, v244, v159
    v_cmp_eq_u32 vcc, -1, v244
    v_mfma_f32_16x16x32_bf16 v[236:239], a[124:127], v[124:127], v[236:239]
L_onx21:
    s_cbranch_vccnz L_osk22
    v_mfma_f32_16x16x32_bf16 v[208:211], a[128:131], v[144:147], v[208:211]
    s_add_u32 s57, s101, 28672
    s_and_b32 s57, s57, 0x7fff
    v_mfma_f32_16x16x32_bf16 v[216:219], a[132:135], v[144:147], v[216:219]
    s_add_u32 s57, s57, s64
    buffer_load_dwordx4 v[192:195], v16, s[20:23], s57 offen offset:0 sc1
    v_mfma_f32_16x16x32_bf16 v[224:227], a[136:139], v[144:147], v[224:227]
    v_mfma_f32_16x16x32_bf16 v[232:235], a[140:143], v[144:147], v[232:235]
    v_mfma_f32_16x16x32_bf16 v[212:215], a[128:131], v[148:151], v[212:215]
    v_mfma_f32_16x16x32_bf16 v[220:223], a[132:135], v[148:151], v[220:223]
    buffer_load_dwordx4 v[196:199], v16, s[20:23], s57 offen offset:1024 sc1
    v_mfma_f32_16x16x32_bf16 v[228:231], a[136:139], v[148:151], v[228:231]
    v_mfma_f32_16x16x32_bf16 v[236:239], a[140:143], v[148:151], v[236:239]
    v_mfma_f32_16x16x32_bf16 v[208:211], a[144:147], v[152:155], v[208:211]
    v_mfma_f32_16x16x32_bf16 v[216:219], a[148:151], v[152:155], v[216:219]
    buffer_load_dwordx4 v[200:203], v16, s[20:23], s57 offen offset:2048 sc1
    v_mfma_f32_16x16x32_bf16 v[224:227], a[152:155], v[152:155], v[224:227]
    s_waitcnt vmcnt(7)
    v_max3_u32 v244, v160, v161, v162
    v_max3_u32 v244, v244, v163, v164
    v_mfma_f32_16x16x32_bf16 v[232:235], a[156:159], v[152:155], v[232:235]
    v_max3_u32 v244, v244, v165, v166
    v_max3_u32 v244, v244, v167, v168
    v_mfma_f32_16x16x32_bf16 v[212:215], a[144:147], v[156:159], v[212:215]
    v_max3_u32 v244, v244, v169, v170
    v_max3_u32 v244, v244, v171, v172
    v_mfma_f32_16x16x32_bf16 v[220:223], a[148:151], v[156:159], v[220:223]
    buffer_load_dwordx4 v[204:207], v16, s[20:23], s57 offen offset:3072 sc1
    v_mfma_f32_16x16x32_bf16 v[228:231], a[152:155], v[156:159], v[228:231]
    v_max3_u32 v244, v244, v173, v174
    v_max_u32 v244, v244, v175
    v_cmp_eq_u32 vcc, -1, v244
    v_mfma_f32_16x16x32_bf16 v[236:239], a[156:159], v[156:159], v[236:239]
L_onx23:
    s_cbranch_vccnz L_osk24
    v_mfma_f32_16x16x32_bf16 v[208:211], a[160:163], v[160:163], v[208:211]
    v_mfma_f32_16x16x32_bf16 v[216:219], a[164:167], v[160:163], v[216:219]
    v_mfma_f32_16x16x32_bf16 v[224:227], a[168:171], v[160:163], v[224:227]
    v_mfma_f32_16x16x32_bf16 v[232:235], a[172:175], v[160:163], v[232:235]
    v_mfma_f32_16x16x32_bf16 v[212:215], a[160:163], v[164:167], v[212:215]
    v_mfma_f32_16x16x32_bf16 v[220:223], a[164:167], v[164:167], v[220:223]
    v_mfma_f32_16x16x32_bf16 v[228:231], a[168:171], v[164:167], v[228:231]
    v_mfma_f32_16x16x32_bf16 v[236:239], a[172:175], v[164:167], v[236:239]
    v_mfma_f32_16x16x32_bf16 v[208:211], a[176:179], v[168:171], v[208:211]
    v_mfma_f32_16x16x32_bf16 v[216:219], a[180:183], v[168:171], v[216:219]
    v_mfma_f32_16x16x32_bf16 v[224:227], a[184:187], v[168:171], v[224:227]
    s_waitcnt vmcnt(4)
    v_max3_u32 v244, v176, v177, v178
    v_max3_u32 v244, v244, v179, v180
    v_mfma_f32_16x16x32_bf16 v[232:235], a[188:191], v[168:171], v[232:235]
    v_max3_u32 v244, v244, v181, v182
    v_max3_u32 v244, v244, v183, v184
    v_mfma_f32_16x16x32_bf16 v[212:215], a[176:179], v[172:175], v[212:215]
    v_max3_u32 v244, v244, v185, v186
    v_max3_u32 v244, v244, v187, v188
    v_mfma_f32_16x16x32_bf16 v[220:223], a[180:183], v[172:175], v[220:223]
    v_max3_u32 v244, v244, v189, v190
    v_max_u32 v244, v244, v191
    v_mfma_f32_16x16x32_bf16 v[228:231], a[184:187], v[172:175], v[228:231]
    v_cmp_eq_u32 vcc, -1, v244
    v_mfma_f32_16x16x32_bf16 v[236:239], a[188:191], v[172:175], v[236:239]
L_onx25:
    s_cmp_lg_u32 s99, 0
    s_cbranch_scc1 L_pre28
L_preo29:
    s_cbranch_vccnz L_osk26
    v_mfma_f32_16x16x32_bf16 v[208:211], a[192:195], v[176:179], v[208:211]
    v_mfma_f32_16x16x32_bf16 v[216:219], a[196:199], v[176:179], v[216:219]
    v_mfma_f32_16x16x32_bf16 v[224:227], a[200:203], v[176:179], v[224:227]
    v_mfma_f32_16x16x32_bf16 v[232:235], a[204:207], v[176:179], v[232:235]
    v_mfma_f32_16x16x32_bf16 v[212:215], a[192:195], v[180:183], v[212:215]
    v_mfma_f32_16x16x32_bf16 v[220:223], a[196:199], v[180:183], v[220:223]
    v_mfma_f32_16x16x32_bf16 v[228:231], a[200:203], v[180:183], v[228:231]
    v_mfma_f32_16x16x32_bf16 v[236:239], a[204:207], v[180:183], v[236:239]
    v_mfma_f32_16x16x32_bf16 v[208:211], a[208:211], v[184:187], v[208:211]
    v_mfma_f32_16x16x32_bf16 v[216:219], a[212:215], v[184:187], v[216:219]
    v_mfma_f32_16x16x32_bf16 v[224:227], a[216:219], v[184:187], v[224:227]
    s_waitcnt vmcnt(0)
    v_max3_u32 v244, v192, v193, v194
    v_max3_u32 v244, v244, v195, v196
    v_mfma_f32_16x16x32_bf16 v[232:235], a[220:223], v[184:187], v[232:235]
    v_max3_u32 v244, v244, v197, v198
    v_max3_u32 v244, v244, v199, v200
    v_mfma_f32_16x16x32_bf16 v[212:215], a[208:211], v[188:191], v[212:215]
    v_max3_u32 v244, v244, v201, v202
    v_max3_u32 v244, v244, v203, v204
    v_mfma_f32_16x16x32_bf16 v[220:223], a[212:215], v[188:191], v[220:223]
    v_max3_u32 v244, v244, v205, v206
    v_max_u32 v244, v244, v207
    v_mfma_f32_16x16x32_bf16 v[228:231], a[216:219], v[188:191], v[228:231]
    v_cmp_eq_u32 vcc, -1, v244
    v_mfma_f32_16x16x32_bf16 v[236:239], a[220:223], v[188:191], v[236:239]
L_onx27:
    s_cbranch_vccnz L_osk30
    v_mfma_f32_16x16x32_bf16 v[224:227], a[232:235], v[192:195], v[224:227]
    v_sub_f32 v43, 1.0, v42
    v_mfma_f32_16x16x32_bf16 v[232:235], a[236:239], v[192:195], v[232:235]
    v_sub_f32 v45, 1.0, v44
    v_mfma_f32_16x16x32_bf16 v[228:231], a[232:235], v[196:199], v[228:231]
    s_cmp_ge_u32 s3, 2
    s_cselect_b64 vcc, -1, 0
    v_mfma_f32_16x16x32_bf16 v[236:239], a[236:239], v[196:199], v[236:239]
    v_cndmask_b32 v42, v42, v43, vcc
    v_mfma_f32_16x16x32_bf16 v[224:227], a[248:251], v[200:203], v[224:227]
    v_cndmask_b32 v44, v44, v45, vcc
    v_mfma_f32_16x16x32_bf16 v[232:235], a[252:255], v[200:203], v[232:235]
    v_mfma_f32_16x16x32_bf16 v[228:231], a[248:251], v[204:207], v[228:231]
    v_mfma_f32_16x16x32_bf16 v[236:239], a[252:255], v[204:207], v[236:239]
    v_mfma_f32_16x16x32_bf16 v[208:211], a[224:227], v[192:195], v[208:211]
    v_mfma_f32_16x16x32_bf16 v[216:219], a[228:231], v[192:195], v[216:219]
    v_mfma_f32_16x16x32_bf16 v[212:215], a[224:227], v[196:199], v[212:215]
    v_mfma_f32_16x16x32_bf16 v[220:223], a[228:231], v[196:199], v[220:223]
    v_mfma_f32_16x16x32_bf16 v[208:211], a[240:243], v[200:203], v[208:211]
    ds_write_b128 v139, v[224:227] offset:0
    v_mfma_f32_16x16x32_bf16 v[216:219], a[244:247], v[200:203], v[216:219]
    ds_write_b128 v139, v[232:235] offset:2048
    v_mfma_f32_16x16x32_bf16 v[212:215], a[240:243], v[204:207], v[212:215]
    ds_write_b128 v139, v[228:231] offset:1024
    v_mfma_f32_16x16x32_bf16 v[220:223], a[244:247], v[204:207], v[220:223]
    ds_write_b128 v139, v[236:239] offset:3072
L_onx31:
    s_cmp_lg_u32 s99, 0
    s_cbranch_scc1 L_ofix234
L_odone33:
    s_waitcnt lgkmcnt(0)
    s_barrier
    ds_read_b128 v[48:51], v47 offset:0
    ds_read_b128 v[56:59], v47 offset:2048
    ds_read_b128 v[52:55], v47 offset:1024
    ds_read_b128 v[60:63], v47 offset:3072
    s_waitcnt lgkmcnt(3)
    v_pk_add_f32 v[208:209], v[208:209], v[48:49] neg_lo:[0,1] neg_hi:[0,1]
    v_pk_fma_f32 v[208:209], v[208:209], v[42:43], v[48:49] op_sel_hi:[1,0,1]
    v_cvt_pk_bf16_f32 v244, v208, v209
    v_pk_add_f32 v[210:211], v[210:211], v[50:51] neg_lo:[0,1] neg_hi:[0,1]
    v_pk_fma_f32 v[210:211], v[210:211], v[42:43], v[50:51] op_sel_hi:[1,0,1]
    v_cvt_pk_bf16_f32 v245, v210, v211
    s_waitcnt lgkmcnt(2)
    v_pk_add_f32 v[216:217], v[216:217], v[56:57] neg_lo:[0,1] neg_hi:[0,1]
    v_pk_fma_f32 v[216:217], v[216:217], v[42:43], v[56:57] op_sel_hi:[1,0,1]
    v_cvt_pk_bf16_f32 v246, v216, v217
    v_pk_add_f32 v[218:219], v[218:219], v[58:59] neg_lo:[0,1] neg_hi:[0,1]
    v_pk_fma_f32 v[218:219], v[218:219], v[42:43], v[58:59] op_sel_hi:[1,0,1]
    v_cvt_pk_bf16_f32 v247, v218, v219
    v_permlane16_swap_b32 v244, v246
    s_nop 0
    v_permlane16_swap_b32 v245, v247
    buffer_store_dwordx4 v[244:247], v138, s[24:27], s47 offen
    s_waitcnt lgkmcnt(1)
    v_pk_add_f32 v[212:213], v[212:213], v[52:53] neg_lo:[0,1] neg_hi:[0,1]
    v_pk_fma_f32 v[212:213], v[212:213], v[44:45], v[52:53] op_sel_hi:[1,0,1]
    v_cvt_pk_bf16_f32 v248, v212, v213
    v_pk_add_f32 v[214:215], v[214:215], v[54:55] neg_lo:[0,1] neg_hi:[0,1]
    v_pk_fma_f32 v[214:215], v[214:215], v[44:45], v[54:55] op_sel_hi:[1,0,1]
    v_cvt_pk_bf16_f32 v249, v214, v215
    s_waitcnt lgkmcnt(0)
    v_pk_add_f32 v[220:221], v[220:221], v[60:61] neg_lo:[0,1] neg_hi:[0,1]
    v_pk_fma_f32 v[220:221], v[220:221], v[44:45], v[60:61] op_sel_hi:[1,0,1]
    v_cvt_pk_bf16_f32 v250, v220, v221
    v_pk_add_f32 v[222:223], v[222:223], v[62:63] neg_lo:[0,1] neg_hi:[0,1]
    v_pk_fma_f32 v[222:223], v[222:223], v[44:45], v[62:63] op_sel_hi:[1,0,1]
    v_cvt_pk_bf16_f32 v251, v222, v223
    v_permlane16_swap_b32 v248, v250
    s_nop 0
    v_permlane16_swap_b32 v249, v251
    s_add_u32 s47, s47, 16384
    buffer_store_dwordx4 v[248:251], v138, s[24:27], s47 offen
L_end:
    s_endpgm
L_ns2:
    s_add_u32 s59, s59, 1
    s_cmp_gt_u32 s59, 65536
    s_cbranch_scc1 L_no3
    buffer_load_dwordx4 v[4:7], v39, s[28:31], 0 offen sc1
    s_waitcnt vmcnt(0)
    v_cmp_eq_u32 vcc, 0, v4
    s_cbranch_vccnz L_ns2
    s_branch L_no3
L_fs6:
    s_add_u32 s59, s59, 1
    s_cmp_gt_u32 s59, 65536
    s_cbranch_scc1 L_fo7
    buffer_load_dwordx2 v[40:41], v17, s[20:23], 0 offen sc1
    s_waitcnt vmcnt(0)
    v_cmp_ne_u64 vcc, v[4:5], v[40:41]
    s_cbranch_vccnz L_fs6
    s_branch L_fo7
L_zslow8:
    s_or_b32 s99, vcc_lo, vcc_hi
    s_lshr_b32 s57, s99, 16
    s_or_b32 s99, s99, s57
    s_lshl_b32 s57, s67, 3
    s_lshr_b32 s99, s99, s57
    s_add_u32 s59, s59, 1
    s_cmp_gt_u32 s59, 65536
    s_cbranch_scc1 L_zok9
    s_add_u32 s57, s62, 4096
    s_waitcnt vmcnt(0)
    buffer_load_dwordx4 v[208:211], v2, s[20:23], s63 offen sc1
    s_bitcmp0_b32 s99, 0
    s_cbranch_scc1 L_zq35
    buffer_load_dwordx4 v[176:179], v16, s[20:23], s62 offen offset:0 sc1
L_zq35:
    s_bitcmp0_b32 s99, 1
    s_cbranch_scc1 L_zq36
    buffer_load_dwordx4 v[180:183], v16, s[20:23], s62 offen offset:1024 sc1
L_zq36:
    s_bitcmp0_b32 s99, 2
    s_cbranch_scc1 L_zq37
    buffer_load_dwordx4 v[184:187], v16, s[20:23], s62 offen offset:2048 sc1
L_zq37:
    s_bitcmp0_b32 s99, 3
    s_cbranch_scc1 L_zq38
    buffer_load_dwordx4 v[188:191], v16, s[20:23], s62 offen offset:3072 sc1
L_zq38:
    s_bitcmp0_b32 s99, 4
    s_cbranch_scc1 L_zq39
    buffer_load_dwordx4 v[192:195], v16, s[20:23], s57 offen offset:0 sc1
L_zq39:
    s_bitcmp0_b32 s99, 5
    s_cbranch_scc1 L_zq40
    buffer_load_dwordx4 v[196:199], v16, s[20:23], s57 offen offset:1024 sc1
L_zq40:
    s_bitcmp0_b32 s99, 6
    s_cbranch_scc1 L_zq41
    buffer_load_dwordx4 v[200:203], v16, s[20:23], s57 offen offset:2048 sc1
L_zq41:
    s_bitcmp0_b32 s99, 7
    s_cbranch_scc1 L_zq42
    buffer_load_dwordx4 v[204:207], v16, s[20:23], s57 offen offset:3072 sc1
L_zq42:
    s_waitcnt vmcnt(0)
    v_max3_u32 v18, v208, v209, v210
    v_max_u32 v18, v18, v211
    v_cmp_eq_u32 vcc, -1, v18
    s_cbranch_vccnz L_zslow8
    s_branch L_zok9
L_gslow10:
    s_add_u32 s59, s59, 1
    s_cmp_gt_u32 s59, 65536
    s_cbranch_scc1 L_gok11
    s_add_u32 s57, s62, 4096
    buffer_load_dwordx4 v[176:179], v16, s[20:23], s62 offen offset:0 sc1
    buffer_load_dwordx4 v[180:183], v16, s[20:23], s62 offen offset:1024 sc1
    buffer_load_dwordx4 v[184:187], v16, s[20:23], s62 offen offset:2048 sc1
    buffer_load_dwordx4 v[188:191], v16, s[20:23], s62 offen offset:3072 sc1
    buffer_load_dwordx4 v[192:195], v16, s[20:23], s57 offen offset:0 sc1
    buffer_load_dwordx4 v[196:199], v16, s[20:23], s57 offen offset:1024 sc1
    buffer_load_dwordx4 v[200:203], v16, s[20:23], s57 offen offset:2048 sc1
    buffer_load_dwordx4 v[204:207], v16, s[20:23], s57 offen offset:3072 sc1
    s_waitcnt vmcnt(0)
    v_max_u32 v20, v176, v177
    v_max3_u32 v20, v20, v178, v179
    v_max3_u32 v20, v20, v180, v181
    v_max3_u32 v20, v20, v182, v183
    v_max3_u32 v20, v20, v184, v185
    v_max3_u32 v20, v20, v186, v187
    v_max3_u32 v20, v20, v188, v189
    v_max3_u32 v20, v20, v190, v191
    v_max3_u32 v20, v20, v192, v193
    v_max3_u32 v20, v20, v194, v195
    v_max3_u32 v20, v20, v196, v197
    v_max3_u32 v20, v20, v198, v199
    v_max3_u32 v20, v20, v200, v201
    v_max3_u32 v20, v20, v202, v203
    v_max3_u32 v20, v20, v204, v205
    v_max3_u32 v20, v20, v206, v207
    v_cmp_eq_u32 vcc, -1, v20
    s_cbranch_vccnz L_gslow10
    v_mfma_f32_16x16x32_bf16 v[224:227], v[134:137], v[176:179], 0
    v_mfma_f32_16x16x32_bf16 v[228:231], v[132:135], v[176:179], 0
    v_mfma_f32_16x16x32_bf16 v[224:227], v[134:137], v[180:183], v[224:227]
    v_mfma_f32_16x16x32_bf16 v[228:231], v[132:135], v[180:183], v[228:231]
    v_mfma_f32_16x16x32_bf16 v[224:227], v[134:137], v[184:187], v[224:227]
    v_mfma_f32_16x16x32_bf16 v[228:231], v[132:135], v[184:187], v[228:231]
    v_mfma_f32_16x16x32_bf16 v[224:227], v[134:137], v[188:191], v[224:227]
    v_mfma_f32_16x16x32_bf16 v[228:231], v[132:135], v[188:191], v[228:231]
    v_mfma_f32_16x16x32_bf16 v[224:227], v[134:137], v[192:195], v[224:227]
    v_mfma_f32_16x16x32_bf16 v[228:231], v[132:135], v[192:195], v[228:231]
    v_mfma_f32_16x16x32_bf16 v[224:227], v[134:137], v[196:199], v[224:227]
    v_mfma_f32_16x16x32_bf16 v[228:231], v[132:135], v[196:199], v[228:231]
    v_mfma_f32_16x16x32_bf16 v[224:227], v[134:137], v[200:203], v[224:227]
    v_mfma_f32_16x16x32_bf16 v[228:231], v[132:135], v[200:203], v[228:231]
    v_mfma_f32_16x16x32_bf16 v[224:227], v[134:137], v[204:207], v[224:227]
    v_mfma_f32_16x16x32_bf16 v[228:231], v[132:135], v[204:207], v[228:231]
    s_nop 15
    s_branch L_gok11
L_hs12:
    s_add_u32 s59, s59, 1
    s_cmp_gt_u32 s59, 65536
    s_cbranch_scc1 L_ho13
    buffer_load_dwordx2 v[40:41], v0, s[20:23], 0 offen sc1
    s_waitcnt vmcnt(0)
    v_cmp_ne_u64 vcc, v[4:5], v[40:41]
    s_cbranch_vccnz L_hs12
    s_branch L_ho13
L_osk14:
    s_bitset1_b32 s99, 0
    s_add_u32 s57, s101, 12288
    s_and_b32 s57, s57, 0x7fff
    s_add_u32 s57, s57, s64
    buffer_load_dwordx4 v[112:115], v16, s[20:23], s57 offen offset:0 sc1
    buffer_load_dwordx4 v[116:119], v16, s[20:23], s57 offen offset:1024 sc1
    buffer_load_dwordx4 v[120:123], v16, s[20:23], s57 offen offset:2048 sc1
    buffer_load_dwordx4 v[124:127], v16, s[20:23], s57 offen offset:3072 sc1
    s_waitcnt vmcnt(11)
    v_max3_u32 v244, v64, v65, v66
    s_waitcnt vmcnt(10)
    v_max3_u32 v244, v244, v67, v68
    v_max3_u32 v244, v244, v69, v70
    s_waitcnt vmcnt(9)
    v_max3_u32 v244, v244, v71, v72
    v_max3_u32 v244, v244, v73, v74
    s_waitcnt vmcnt(8)
    v_max3_u32 v244, v244, v75, v76
    v_max3_u32 v244, v244, v77, v78
    v_max_u32 v244, v244, v79
    v_cmp_eq_u32 vcc, -1, v244
    s_branch L_onx15
L_osk16:
    s_bitset1_b32 s99, 1
    s_add_u32 s57, s101, 16384
    s_and_b32 s57, s57, 0x7fff
    s_add_u32 s57, s57, s64
    buffer_load_dwordx4 v[144:147], v16, s[20:23], s57 offen offset:0 sc1
    buffer_load_dwordx4 v[148:151], v16, s[20:23], s57 offen offset:1024 sc1
    buffer_load_dwordx4 v[152:155], v16, s[20:23], s57 offen offset:2048 sc1
    buffer_load_dwordx4 v[156:159], v16, s[20:23], s57 offen offset:3072 sc1
    s_waitcnt vmcnt(11)
    v_max3_u32 v244, v80, v81, v82
    s_waitcnt vmcnt(10)
    v_max3_u32 v244, v244, v83, v84
    v_max3_u32 v244, v244, v85, v86
    s_waitcnt vmcnt(9)
    v_max3_u32 v244, v244, v87, v88
    v_max3_u32 v244, v244, v89, v90
    s_waitcnt vmcnt(8)
    v_max3_u32 v244, v244, v91, v92
    v_max3_u32 v244, v244, v93, v94
    v_max_u32 v244, v244, v95
    v_cmp_eq_u32 vcc, -1, v244
    s_branch L_onx17
L_osk18:
    s_bitset1_b32 s99, 2
    s_add_u32 s57, s101, 20480
    s_and_b32 s57, s57, 0x7fff
    s_add_u32 s57, s57, s64
    buffer_load_dwordx4 v[160:163], v16, s[20:23], s57 offen offset:0 sc1
    buffer_load_dwordx4 v[164:167], v16, s[20:23], s57 offen offset:1024 sc1
    buffer_load_dwordx4 v[168:171], v16, s[20:23], s57 offen offset:2048 sc1
    buffer_load_dwordx4 v[172:175], v16, s[20:23], s57 offen offset:3072 sc1
    s_waitcnt vmcnt(11)
    v_max3_u32 v244, v112, v113, v114
    s_waitcnt vmcnt(10)
    v_max3_u32 v244, v244, v115, v116
    v_max3_u32 v244, v244, v117, v118
    s_waitcnt vmcnt(9)
    v_max3_u32 v244, v244, v119, v120
    v_max3_u32 v244, v244, v121, v122
    s_waitcnt vmcnt(8)
    v_max3_u32 v244, v244, v123, v124
    v_max3_u32 v244, v244, v125, v126
    v_max_u32 v244, v244, v127
    v_cmp_eq_u32 vcc, -1, v244
    s_branch L_onx19
L_osk20:
    s_bitset1_b32 s99, 3
    s_add_u32 s57, s101, 24576
    s_and_b32 s57, s57, 0x7fff
    s_add_u32 s57, s57, s64
    buffer_load_dwordx4 v[176:179], v16, s[20:23], s57 offen offset:0 sc1
    buffer_load_dwordx4 v[180:183], v16, s[20:23], s57 offen offset:1024 sc1
    buffer_load_dwordx4 v[184:187], v16, s[20:23], s57 offen offset:2048 sc1
    buffer_load_dwordx4 v[188:191], v16, s[20:23], s57 offen offset:3072 sc1
    s_waitcnt vmcnt(11)
    v_max3_u32 v244, v144, v145, v146
    s_waitcnt vmcnt(10)
    v_max3_u32 v244, v244, v147, v148
    v_max3_u32 v244, v244, v149, v150
    s_waitcnt vmcnt(9)
    v_max3_u32 v244, v244, v151, v152
    v_max3_u32 v244, v244, v153, v154
    s_waitcnt vmcnt(8)
    v_max3_u32 v244, v244, v155, v156
    v_max3_u32 v244, v244, v157, v158
    v_max_u32 v244, v244, v159
    v_cmp_eq_u32 vcc, -1, v244
    s_branch L_onx21
L_osk22:
    s_bitset1_b32 s99, 4
    s_add_u32 s57, s101, 28672
    s_and_b32 s57, s57, 0x7fff
    s_add_u32 s57, s57, s64
    buffer_load_dwordx4 v[192:195], v16, s[20:23], s57 offen offset:0 sc1
    buffer_load_dwordx4 v[196:199], v16, s[20:23], s57 offen offset:1024 sc1
    buffer_load_dwordx4 v[200:203], v16, s[20:23], s57 offen offset:2048 sc1
    buffer_load_dwordx4 v[204:207], v16, s[20:23], s57 offen offset:3072 sc1
    s_waitcnt vmcnt(11)
    v_max3_u32 v244, v160, v161, v162
    s_waitcnt vmcnt(10)
    v_max3_u32 v244, v244, v163, v164
    v_max3_u32 v244, v244, v165, v166
    s_waitcnt vmcnt(9)
    v_max3_u32 v244, v244, v167, v168
    v_max3_u32 v244, v244, v169, v170
    s_waitcnt vmcnt(8)
    v_max3_u32 v244, v244, v171, v172
    v_max3_u32 v244, v244, v173, v174
    v_max_u32 v244, v244, v175
    v_cmp_eq_u32 vcc, -1, v244
    s_branch L_onx23
L_osk24:
    s_bitset1_b32 s99, 5
    s_waitcnt vmcnt(7)
    v_max3_u32 v244, v176, v177, v178
    s_waitcnt vmcnt(6)
    v_max3_u32 v244, v244, v179, v180
    v_max3_u32 v244, v244, v181, v182
    s_waitcnt vmcnt(5)
    v_max3_u32 v244, v244, v183, v184
    v_max3_u32 v244, v244, v185, v186
    s_waitcnt vmcnt(4)
    v_max3_u32 v244, v244, v187, v188
    v_max3_u32 v244, v244, v189, v190
    v_max_u32 v244, v244, v191
    v_cmp_eq_u32 vcc, -1, v244
    s_branch L_onx25
L_pre28:
    s_bitcmp0_b32 s99, 0
    s_cbranch_scc1 L_pl43
    s_add_u32 s57, s101, 0
    s_and_b32 s57, s57, 0x7fff
    s_add_u32 s57, s57, s64
    buffer_load_dwordx4 v[48:51], v16, s[20:23], s57 offen offset:0 sc1
    buffer_load_dwordx4 v[52:55], v16, s[20:23], s57 offen offset:1024 sc1
    buffer_load_dwordx4 v[56:59], v16, s[20:23], s57 offen offset:2048 sc1
    buffer_load_dwordx4 v[60:63], v16, s[20:23], s57 offen offset:3072 sc1
L_pl43:
    s_bitcmp0_b32 s99, 1
    s_cbranch_scc1 L_pl44
    s_add_u32 s57, s101, 4096
    s_and_b32 s57, s57, 0x7fff
    s_add_u32 s57, s57, s64
    buffer_load_dwordx4 v[64:67], v16, s[20:23], s57 offen offset:0 sc1
    buffer_load_dwordx4 v[68:71], v16, s[20:23], s57 offen offset:1024 sc1
    buffer_load_dwordx4 v[72:75], v16, s[20:23], s57 offen offset:2048 sc1
    buffer_load_dwordx4 v[76:79], v16, s[20:23], s57 offen offset:3072 sc1
L_pl44:
    s_bitcmp0_b32 s99, 2
    s_cbranch_scc1 L_pl45
    s_add_u32 s57, s101, 8192
    s_and_b32 s57, s57, 0x7fff
    s_add_u32 s57, s57, s64
    buffer_load_dwordx4 v[80:83], v16, s[20:23], s57 offen offset:0 sc1
    buffer_load_dwordx4 v[84:87], v16, s[20:23], s57 offen offset:1024 sc1
    buffer_load_dwordx4 v[88:91], v16, s[20:23], s57 offen offset:2048 sc1
    buffer_load_dwordx4 v[92:95], v16, s[20:23], s57 offen offset:3072 sc1
L_pl45:
    s_bitcmp0_b32 s99, 3
    s_cbranch_scc1 L_pl46
    s_add_u32 s57, s101, 12288
    s_and_b32 s57, s57, 0x7fff
    s_add_u32 s57, s57, s64
    buffer_load_dwordx4 v[112:115], v16, s[20:23], s57 offen offset:0 sc1
    buffer_load_dwordx4 v[116:119], v16, s[20:23], s57 offen offset:1024 sc1
    buffer_load_dwordx4 v[120:123], v16, s[20:23], s57 offen offset:2048 sc1
    buffer_load_dwordx4 v[124:127], v16, s[20:23], s57 offen offset:3072 sc1
L_pl46:
    s_bitcmp0_b32 s99, 4
    s_cbranch_scc1 L_pl47
    s_add_u32 s57, s101, 16384
    s_and_b32 s57, s57, 0x7fff
    s_add_u32 s57, s57, s64
    buffer_load_dwordx4 v[144:147], v16, s[20:23], s57 offen offset:0 sc1
    buffer_load_dwordx4 v[148:151], v16, s[20:23], s57 offen offset:1024 sc1
    buffer_load_dwordx4 v[152:155], v16, s[20:23], s57 offen offset:2048 sc1
    buffer_load_dwordx4 v[156:159], v16, s[20:23], s57 offen offset:3072 sc1
L_pl47:
    s_bitcmp0_b32 s99, 5
    s_cbranch_scc1 L_pl48
    s_add_u32 s57, s101, 20480
    s_and_b32 s57, s57, 0x7fff
    s_add_u32 s57, s57, s64
    buffer_load_dwordx4 v[160:163], v16, s[20:23], s57 offen offset:0 sc1
    buffer_load_dwordx4 v[164:167], v16, s[20:23], s57 offen offset:1024 sc1
    buffer_load_dwordx4 v[168:171], v16, s[20:23], s57 offen offset:2048 sc1
    buffer_load_dwordx4 v[172:175], v16, s[20:23], s57 offen offset:3072 sc1
L_pl48:
    s_branch L_preo29
L_osk26:
    s_bitset1_b32 s99, 6
    s_add_u32 s57, s101, 24576
    s_and_b32 s57, s57, 0x7fff
    s_add_u32 s57, s57, s64
    buffer_load_dwordx4 v[176:179], v16, s[20:23], s57 offen offset:0 sc1
    buffer_load_dwordx4 v[180:183], v16, s[20:23], s57 offen offset:1024 sc1
    buffer_load_dwordx4 v[184:187], v16, s[20:23], s57 offen offset:2048 sc1
    buffer_load_dwordx4 v[188:191], v16, s[20:23], s57 offen offset:3072 sc1
    s_waitcnt vmcnt(3)
    v_max3_u32 v244, v192, v193, v194
    s_waitcnt vmcnt(2)
    v_max3_u32 v244, v244, v195, v196
    v_max3_u32 v244, v244, v197, v198
    s_waitcnt vmcnt(1)
    v_max3_u32 v244, v244, v199, v200
    v_max3_u32 v244, v244, v201, v202
    s_waitcnt vmcnt(0)
    v_max3_u32 v244, v244, v203, v204
    v_max3_u32 v244, v244, v205, v206
    v_max_u32 v244, v244, v207
    v_cmp_eq_u32 vcc, -1, v244
    s_branch L_onx27
L_osk30:
    s_bitset1_b32 s99, 7
    s_add_u32 s57, s101, 28672
    s_and_b32 s57, s57, 0x7fff
    s_add_u32 s57, s57, s64
    buffer_load_dwordx4 v[192:195], v16, s[20:23], s57 offen offset:0 sc1
    buffer_load_dwordx4 v[196:199], v16, s[20:23], s57 offen offset:1024 sc1
    buffer_load_dwordx4 v[200:203], v16, s[20:23], s57 offen offset:2048 sc1
    buffer_load_dwordx4 v[204:207], v16, s[20:23], s57 offen offset:3072 sc1
    v_sub_f32 v43, 1.0, v42
    v_sub_f32 v45, 1.0, v44
    s_cmp_ge_u32 s3, 2
    s_cselect_b64 vcc, -1, 0
    v_cndmask_b32 v42, v42, v43, vcc
    v_cndmask_b32 v44, v44, v45, vcc
    s_branch L_onx31
L_ofix32:
    s_add_u32 s59, s59, 0x100
    s_cmp_gt_u32 s59, 16777216
    s_cbranch_scc1 L_odone33
    s_bitcmp0_b32 s99, 0
    s_cbranch_scc1 L_fl49
    s_add_u32 s57, s101, 0
    s_and_b32 s57, s57, 0x7fff
    s_add_u32 s57, s57, s64
    buffer_load_dwordx4 v[48:51], v16, s[20:23], s57 offen offset:0 sc1
    buffer_load_dwordx4 v[52:55], v16, s[20:23], s57 offen offset:1024 sc1
    buffer_load_dwordx4 v[56:59], v16, s[20:23], s57 offen offset:2048 sc1
    buffer_load_dwordx4 v[60:63], v16, s[20:23], s57 offen offset:3072 sc1
L_fl49:
    s_bitcmp0_b32 s99, 1
    s_cbranch_scc1 L_fl50
    s_add_u32 s57, s101, 4096
    s_and_b32 s57, s57, 0x7fff
    s_add_u32 s57, s57, s64
    buffer_load_dwordx4 v[64:67], v16, s[20:23], s57 offen offset:0 sc1
    buffer_load_dwordx4 v[68:71], v16, s[20:23], s57 offen offset:1024 sc1
    buffer_load_dwordx4 v[72:75], v16, s[20:23], s57 offen offset:2048 sc1
    buffer_load_dwordx4 v[76:79], v16, s[20:23], s57 offen offset:3072 sc1
L_fl50:
    s_bitcmp0_b32 s99, 2
    s_cbranch_scc1 L_fl51
    s_add_u32 s57, s101, 8192
    s_and_b32 s57, s57, 0x7fff
    s_add_u32 s57, s57, s64
    buffer_load_dwordx4 v[80:83], v16, s[20:23], s57 offen offset:0 sc1
    buffer_load_dwordx4 v[84:87], v16, s[20:23], s57 offen offset:1024 sc1
    buffer_load_dwordx4 v[88:91], v16, s[20:23], s57 offen offset:2048 sc1
    buffer_load_dwordx4 v[92:95], v16, s[20:23], s57 offen offset:3072 sc1
L_fl51:
    s_bitcmp0_b32 s99, 3
    s_cbranch_scc1 L_fl52
    s_add_u32 s57, s101, 12288
    s_and_b32 s57, s57, 0x7fff
    s_add_u32 s57, s57, s64
    buffer_load_dwordx4 v[112:115], v16, s[20:23], s57 offen offset:0 sc1
    buffer_load_dwordx4 v[116:119], v16, s[20:23], s57 offen offset:1024 sc1
    buffer_load_dwordx4 v[120:123], v16, s[20:23], s57 offen offset:2048 sc1
    buffer_load_dwordx4 v[124:127], v16, s[20:23], s57 offen offset:3072 sc1
L_fl52:
    s_bitcmp0_b32 s99, 4
    s_cbranch_scc1 L_fl53
    s_add_u32 s57, s101, 16384
    s_and_b32 s57, s57, 0x7fff
    s_add_u32 s57, s57, s64
    buffer_load_dwordx4 v[144:147], v16, s[20:23], s57 offen offset:0 sc1
    buffer_load_dwordx4 v[148:151], v16, s[20:23], s57 offen offset:1024 sc1
    buffer_load_dwordx4 v[152:155], v16, s[20:23], s57 offen offset:2048 sc1
    buffer_load_dwordx4 v[156:159], v16, s[20:23], s57 offen offset:3072 sc1
L_fl53:
    s_bitcmp0_b32 s99, 5
    s_cbranch_scc1 L_fl54
    s_add_u32 s57, s101, 20480
    s_and_b32 s57, s57, 0x7fff
    s_add_u32 s57, s57, s64
    buffer_load_dwordx4 v[160:163], v16, s[20:23], s57 offen offset:0 sc1
    buffer_load_dwordx4 v[164:167], v16, s[20:23], s57 offen offset:1024 sc1
    buffer_load_dwordx4 v[168:171], v16, s[20:23], s57 offen offset:2048 sc1
    buffer_load_dwordx4 v[172:175], v16, s[20:23], s57 offen offset:3072 sc1
L_fl54:
    s_bitcmp0_b32 s99, 6
    s_cbranch_scc1 L_fl55
    s_add_u32 s57, s101, 24576
    s_and_b32 s57, s57, 0x7fff
    s_add_u32 s57, s57, s64
    buffer_load_dwordx4 v[176:179], v16, s[20:23], s57 offen offset:0 sc1
    buffer_load_dwordx4 v[180:183], v16, s[20:23], s57 offen offset:1024 sc1
    buffer_load_dwordx4 v[184:187], v16, s[20:23], s57 offen offset:2048 sc1
    buffer_load_dwordx4 v[188:191], v16, s[20:23], s57 offen offset:3072 sc1
L_fl55:
    s_bitcmp0_b32 s99, 7
    s_cbranch_scc1 L_fl56
    s_add_u32 s57, s101, 28672
    s_and_b32 s57, s57, 0x7fff
    s_add_u32 s57, s57, s64
    buffer_load_dwordx4 v[192:195], v16, s[20:23], s57 offen offset:0 sc1
    buffer_load_dwordx4 v[196:199], v16, s[20:23], s57 offen offset:1024 sc1
    buffer_load_dwordx4 v[200:203], v16, s[20:23], s57 offen offset:2048 sc1
    buffer_load_dwordx4 v[204:207], v16, s[20:23], s57 offen offset:3072 sc1
L_fl56:
L_ofix234:
    s_waitcnt vmcnt(0)
    s_bitcmp0_b32 s99, 0
    s_cbranch_scc1 L_fm57
    v_max3_u32 v244, v48, v49, v50
    v_max3_u32 v244, v244, v51, v52
    v_max3_u32 v244, v244, v53, v54
    v_max3_u32 v244, v244, v55, v56
    v_max3_u32 v244, v244, v57, v58
    v_max3_u32 v244, v244, v59, v60
    v_max3_u32 v244, v244, v61, v62
    v_max_u32 v244, v244, v63
    v_cmp_eq_u32 vcc, -1, v244
    s_cbranch_vccnz L_fm57
    s_bitset0_b32 s99, 0
    v_mfma_f32_16x16x32_bf16 v[208:211], a[0:3], v[48:51], v[208:211]
    v_mfma_f32_16x16x32_bf16 v[216:219], a[4:7], v[48:51], v[216:219]
    v_mfma_f32_16x16x32_bf16 v[224:227], a[8:11], v[48:51], v[224:227]
    v_mfma_f32_16x16x32_bf16 v[232:235], a[12:15], v[48:51], v[232:235]
    v_mfma_f32_16x16x32_bf16 v[212:215], a[0:3], v[52:55], v[212:215]
    v_mfma_f32_16x16x32_bf16 v[220:223], a[4:7], v[52:55], v[220:223]
    v_mfma_f32_16x16x32_bf16 v[228:231], a[8:11], v[52:55], v[228:231]
    v_mfma_f32_16x16x32_bf16 v[236:239], a[12:15], v[52:55], v[236:239]
    v_mfma_f32_16x16x32_bf16 v[208:211], a[16:19], v[56:59], v[208:211]
    v_mfma_f32_16x16x32_bf16 v[216:219], a[20:23], v[56:59], v[216:219]
    v_mfma_f32_16x16x32_bf16 v[224:227], a[24:27], v[56:59], v[224:227]
    v_mfma_f32_16x16x32_bf16 v[232:235], a[28:31], v[56:59], v[232:235]
    v_mfma_f32_16x16x32_bf16 v[212:215], a[16:19], v[60:63], v[212:215]
    v_mfma_f32_16x16x32_bf16 v[220:223], a[20:23], v[60:63], v[220:223]
    v_mfma_f32_16x16x32_bf16 v[228:231], a[24:27], v[60:63], v[228:231]
    v_mfma_f32_16x16x32_bf16 v[236:239], a[28:31], v[60:63], v[236:239]
L_fm57:
    s_bitcmp0_b32 s99, 1
    s_cbranch_scc1 L_fm58
    v_max3_u32 v244, v64, v65, v66
    v_max3_u32 v244, v244, v67, v68
    v_max3_u32 v244, v244, v69, v70
    v_max3_u32 v244, v244, v71, v72
    v_max3_u32 v244, v244, v73, v74
    v_max3_u32 v244, v244, v75, v76
    v_max3_u32 v244, v244, v77, v78
    v_max_u32 v244, v244, v79
    v_cmp_eq_u32 vcc, -1, v244
    s_cbranch_vccnz L_fm58
    s_bitset0_b32 s99, 1
    v_mfma_f32_16x16x32_bf16 v[208:211], a[32:35], v[64:67], v[208:211]
    v_mfma_f32_16x16x32_bf16 v[216:219], a[36:39], v[64:67], v[216:219]
    v_mfma_f32_16x16x32_bf16 v[224:227], a[40:43], v[64:67], v[224:227]
    v_mfma_f32_16x16x32_bf16 v[232:235], a[44:47], v[64:67], v[232:235]
    v_mfma_f32_16x16x32_bf16 v[212:215], a[32:35], v[68:71], v[212:215]
    v_mfma_f32_16x16x32_bf16 v[220:223], a[36:39], v[68:71], v[220:223]
    v_mfma_f32_16x16x32_bf16 v[228:231], a[40:43], v[68:71], v[228:231]
    v_mfma_f32_16x16x32_bf16 v[236:239], a[44:47], v[68:71], v[236:239]
    v_mfma_f32_16x16x32_bf16 v[208:211], a[48:51], v[72:75], v[208:211]
    v_mfma_f32_16x16x32_bf16 v[216:219], a[52:55], v[72:75], v[216:219]
    v_mfma_f32_16x16x32_bf16 v[224:227], a[56:59], v[72:75], v[224:227]
    v_mfma_f32_16x16x32_bf16 v[232:235], a[60:63], v[72:75], v[232:235]
    v_mfma_f32_16x16x32_bf16 v[212:215], a[48:51], v[76:79], v[212:215]
    v_mfma_f32_16x16x32_bf16 v[220:223], a[52:55], v[76:79], v[220:223]
    v_mfma_f32_16x16x32_bf16 v[228:231], a[56:59], v[76:79], v[228:231]
    v_mfma_f32_16x16x32_bf16 v[236:239], a[60:63], v[76:79], v[236:239]
L_fm58:
    s_bitcmp0_b32 s99, 2
    s_cbranch_scc1 L_fm59
    v_max3_u32 v244, v80, v81, v82
    v_max3_u32 v244, v244, v83, v84
    v_max3_u32 v244, v244, v85, v86
    v_max3_u32 v244, v244, v87, v88
    v_max3_u32 v244, v244, v89, v90
    v_max3_u32 v244, v244, v91, v92
    v_max3_u32 v244, v244, v93, v94
    v_max_u32 v244, v244, v95
    v_cmp_eq_u32 vcc, -1, v244
    s_cbranch_vccnz L_fm59
    s_bitset0_b32 s99, 2
    v_mfma_f32_16x16x32_bf16 v[208:211], a[64:67], v[80:83], v[208:211]
    v_mfma_f32_16x16x32_bf16 v[216:219], a[68:71], v[80:83], v[216:219]
    v_mfma_f32_16x16x32_bf16 v[224:227], a[72:75], v[80:83], v[224:227]
    v_mfma_f32_16x16x32_bf16 v[232:235], a[76:79], v[80:83], v[232:235]
    v_mfma_f32_16x16x32_bf16 v[212:215], a[64:67], v[84:87], v[212:215]
    v_mfma_f32_16x16x32_bf16 v[220:223], a[68:71], v[84:87], v[220:223]
    v_mfma_f32_16x16x32_bf16 v[228:231], a[72:75], v[84:87], v[228:231]
    v_mfma_f32_16x16x32_bf16 v[236:239], a[76:79], v[84:87], v[236:239]
    v_mfma_f32_16x16x32_bf16 v[208:211], a[80:83], v[88:91], v[208:211]
    v_mfma_f32_16x16x32_bf16 v[216:219], a[84:87], v[88:91], v[216:219]
    v_mfma_f32_16x16x32_bf16 v[224:227], a[88:91], v[88:91], v[224:227]
    v_mfma_f32_16x16x32_bf16 v[232:235], a[92:95], v[88:91], v[232:235]
    v_mfma_f32_16x16x32_bf16 v[212:215], a[80:83], v[92:95], v[212:215]
    v_mfma_f32_16x16x32_bf16 v[220:223], a[84:87], v[92:95], v[220:223]
    v_mfma_f32_16x16x32_bf16 v[228:231], a[88:91], v[92:95], v[228:231]
    v_mfma_f32_16x16x32_bf16 v[236:239], a[92:95], v[92:95], v[236:239]
L_fm59:
    s_bitcmp0_b32 s99, 3
    s_cbranch_scc1 L_fm60
    v_max3_u32 v244, v112, v113, v114
    v_max3_u32 v244, v244, v115, v116
    v_max3_u32 v244, v244, v117, v118
    v_max3_u32 v244, v244, v119, v120
    v_max3_u32 v244, v244, v121, v122
    v_max3_u32 v244, v244, v123, v124
    v_max3_u32 v244, v244, v125, v126
    v_max_u32 v244, v244, v127
    v_cmp_eq_u32 vcc, -1, v244
    s_cbranch_vccnz L_fm60
    s_bitset0_b32 s99, 3
    v_mfma_f32_16x16x32_bf16 v[208:211], a[96:99], v[112:115], v[208:211]
    v_mfma_f32_16x16x32_bf16 v[216:219], a[100:103], v[112:115], v[216:219]
    v_mfma_f32_16x16x32_bf16 v[224:227], a[104:107], v[112:115], v[224:227]
    v_mfma_f32_16x16x32_bf16 v[232:235], a[108:111], v[112:115], v[232:235]
    v_mfma_f32_16x16x32_bf16 v[212:215], a[96:99], v[116:119], v[212:215]
    v_mfma_f32_16x16x32_bf16 v[220:223], a[100:103], v[116:119], v[220:223]
    v_mfma_f32_16x16x32_bf16 v[228:231], a[104:107], v[116:119], v[228:231]
    v_mfma_f32_16x16x32_bf16 v[236:239], a[108:111], v[116:119], v[236:239]
    v_mfma_f32_16x16x32_bf16 v[208:211], a[112:115], v[120:123], v[208:211]
    v_mfma_f32_16x16x32_bf16 v[216:219], a[116:119], v[120:123], v[216:219]
    v_mfma_f32_16x16x32_bf16 v[224:227], a[120:123], v[120:123], v[224:227]
    v_mfma_f32_16x16x32_bf16 v[232:235], a[124:127], v[120:123], v[232:235]
    v_mfma_f32_16x16x32_bf16 v[212:215], a[112:115], v[124:127], v[212:215]
    v_mfma_f32_16x16x32_bf16 v[220:223], a[116:119], v[124:127], v[220:223]
    v_mfma_f32_16x16x32_bf16 v[228:231], a[120:123], v[124:127], v[228:231]
    v_mfma_f32_16x16x32_bf16 v[236:239], a[124:127], v[124:127], v[236:239]
L_fm60:
    s_bitcmp0_b32 s99, 4
    s_cbranch_scc1 L_fm61
    v_max3_u32 v244, v144, v145, v146
    v_max3_u32 v244, v244, v147, v148
    v_max3_u32 v244, v244, v149, v150
    v_max3_u32 v244, v244, v151, v152
    v_max3_u32 v244, v244, v153, v154
    v_max3_u32 v244, v244, v155, v156
    v_max3_u32 v244, v244, v157, v158
    v_max_u32 v244, v244, v159
    v_cmp_eq_u32 vcc, -1, v244
    s_cbranch_vccnz L_fm61
    s_bitset0_b32 s99, 4
    v_mfma_f32_16x16x32_bf16 v[208:211], a[128:131], v[144:147], v[208:211]
    v_mfma_f32_16x16x32_bf16 v[216:219], a[132:135], v[144:147], v[216:219]
    v_mfma_f32_16x16x32_bf16 v[224:227], a[136:139], v[144:147], v[224:227]
    v_mfma_f32_16x16x32_bf16 v[232:235], a[140:143], v[144:147], v[232:235]
    v_mfma_f32_16x16x32_bf16 v[212:215], a[128:131], v[148:151], v[212:215]
    v_mfma_f32_16x16x32_bf16 v[220:223], a[132:135], v[148:151], v[220:223]
    v_mfma_f32_16x16x32_bf16 v[228:231], a[136:139], v[148:151], v[228:231]
    v_mfma_f32_16x16x32_bf16 v[236:239], a[140:143], v[148:151], v[236:239]
    v_mfma_f32_16x16x32_bf16 v[208:211], a[144:147], v[152:155], v[208:211]
    v_mfma_f32_16x16x32_bf16 v[216:219], a[148:151], v[152:155], v[216:219]
    v_mfma_f32_16x16x32_bf16 v[224:227], a[152:155], v[152:155], v[224:227]
    v_mfma_f32_16x16x32_bf16 v[232:235], a[156:159], v[152:155], v[232:235]
    v_mfma_f32_16x16x32_bf16 v[212:215], a[144:147], v[156:159], v[212:215]
    v_mfma_f32_16x16x32_bf16 v[220:223], a[148:151], v[156:159], v[220:223]
    v_mfma_f32_16x16x32_bf16 v[228:231], a[152:155], v[156:159], v[228:231]
    v_mfma_f32_16x16x32_bf16 v[236:239], a[156:159], v[156:159], v[236:239]
L_fm61:
    s_bitcmp0_b32 s99, 5
    s_cbranch_scc1 L_fm62
    v_max3_u32 v244, v160, v161, v162
    v_max3_u32 v244, v244, v163, v164
    v_max3_u32 v244, v244, v165, v166
    v_max3_u32 v244, v244, v167, v168
    v_max3_u32 v244, v244, v169, v170
    v_max3_u32 v244, v244, v171, v172
    v_max3_u32 v244, v244, v173, v174
    v_max_u32 v244, v244, v175
    v_cmp_eq_u32 vcc, -1, v244
    s_cbranch_vccnz L_fm62
    s_bitset0_b32 s99, 5
    v_mfma_f32_16x16x32_bf16 v[208:211], a[160:163], v[160:163], v[208:211]
    v_mfma_f32_16x16x32_bf16 v[216:219], a[164:167], v[160:163], v[216:219]
    v_mfma_f32_16x16x32_bf16 v[224:227], a[168:171], v[160:163], v[224:227]
    v_mfma_f32_16x16x32_bf16 v[232:235], a[172:175], v[160:163], v[232:235]
    v_mfma_f32_16x16x32_bf16 v[212:215], a[160:163], v[164:167], v[212:215]
    v_mfma_f32_16x16x32_bf16 v[220:223], a[164:167], v[164:167], v[220:223]
    v_mfma_f32_16x16x32_bf16 v[228:231], a[168:171], v[164:167], v[228:231]
    v_mfma_f32_16x16x32_bf16 v[236:239], a[172:175], v[164:167], v[236:239]
    v_mfma_f32_16x16x32_bf16 v[208:211], a[176:179], v[168:171], v[208:211]
    v_mfma_f32_16x16x32_bf16 v[216:219], a[180:183], v[168:171], v[216:219]
    v_mfma_f32_16x16x32_bf16 v[224:227], a[184:187], v[168:171], v[224:227]
    v_mfma_f32_16x16x32_bf16 v[232:235], a[188:191], v[168:171], v[232:235]
    v_mfma_f32_16x16x32_bf16 v[212:215], a[176:179], v[172:175], v[212:215]
    v_mfma_f32_16x16x32_bf16 v[220:223], a[180:183], v[172:175], v[220:223]
    v_mfma_f32_16x16x32_bf16 v[228:231], a[184:187], v[172:175], v[228:231]
    v_mfma_f32_16x16x32_bf16 v[236:239], a[188:191], v[172:175], v[236:239]
L_fm62:
    s_bitcmp0_b32 s99, 6
    s_cbranch_scc1 L_fm63
    v_max3_u32 v244, v176, v177, v178
    v_max3_u32 v244, v244, v179, v180
    v_max3_u32 v244, v244, v181, v182
    v_max3_u32 v244, v244, v183, v184
    v_max3_u32 v244, v244, v185, v186
    v_max3_u32 v244, v244, v187, v188
    v_max3_u32 v244, v244, v189, v190
    v_max_u32 v244, v244, v191
    v_cmp_eq_u32 vcc, -1, v244
    s_cbranch_vccnz L_fm63
    s_bitset0_b32 s99, 6
    v_mfma_f32_16x16x32_bf16 v[208:211], a[192:195], v[176:179], v[208:211]
    v_mfma_f32_16x16x32_bf16 v[216:219], a[196:199], v[176:179], v[216:219]
    v_mfma_f32_16x16x32_bf16 v[224:227], a[200:203], v[176:179], v[224:227]
    v_mfma_f32_16x16x32_bf16 v[232:235], a[204:207], v[176:179], v[232:235]
    v_mfma_f32_16x16x32_bf16 v[212:215], a[192:195], v[180:183], v[212:215]
    v_mfma_f32_16x16x32_bf16 v[220:223], a[196:199], v[180:183], v[220:223]
    v_mfma_f32_16x16x32_bf16 v[228:231], a[200:203], v[180:183], v[228:231]
    v_mfma_f32_16x16x32_bf16 v[236:239], a[204:207], v[180:183], v[236:239]
    v_mfma_f32_16x16x32_bf16 v[208:211], a[208:211], v[184:187], v[208:211]
    v_mfma_f32_16x16x32_bf16 v[216:219], a[212:215], v[184:187], v[216:219]
    v_mfma_f32_16x16x32_bf16 v[224:227], a[216:219], v[184:187], v[224:227]
    v_mfma_f32_16x16x32_bf16 v[232:235], a[220:223], v[184:187], v[232:235]
    v_mfma_f32_16x16x32_bf16 v[212:215], a[208:211], v[188:191], v[212:215]
    v_mfma_f32_16x16x32_bf16 v[220:223], a[212:215], v[188:191], v[220:223]
    v_mfma_f32_16x16x32_bf16 v[228:231], a[216:219], v[188:191], v[228:231]
    v_mfma_f32_16x16x32_bf16 v[236:239], a[220:223], v[188:191], v[236:239]
L_fm63:
    s_bitcmp0_b32 s99, 7
    s_cbranch_scc1 L_fm64
    v_max3_u32 v244, v192, v193, v194
    v_max3_u32 v244, v244, v195, v196
    v_max3_u32 v244, v244, v197, v198
    v_max3_u32 v244, v244, v199, v200
    v_max3_u32 v244, v244, v201, v202
    v_max3_u32 v244, v244, v203, v204
    v_max3_u32 v244, v244, v205, v206
    v_max_u32 v244, v244, v207
    v_cmp_eq_u32 vcc, -1, v244
    s_cbranch_vccnz L_fm64
    s_bitset0_b32 s99, 7
    v_mfma_f32_16x16x32_bf16 v[208:211], a[224:227], v[192:195], v[208:211]
    v_mfma_f32_16x16x32_bf16 v[216:219], a[228:231], v[192:195], v[216:219]
    v_mfma_f32_16x16x32_bf16 v[224:227], a[232:235], v[192:195], v[224:227]
    v_mfma_f32_16x16x32_bf16 v[232:235], a[236:239], v[192:195], v[232:235]
    v_mfma_f32_16x16x32_bf16 v[212:215], a[224:227], v[196:199], v[212:215]
    v_mfma_f32_16x16x32_bf16 v[220:223], a[228:231], v[196:199], v[220:223]
    v_mfma_f32_16x16x32_bf16 v[228:231], a[232:235], v[196:199], v[228:231]
    v_mfma_f32_16x16x32_bf16 v[236:239], a[236:239], v[196:199], v[236:239]
    v_mfma_f32_16x16x32_bf16 v[208:211], a[240:243], v[200:203], v[208:211]
    v_mfma_f32_16x16x32_bf16 v[216:219], a[244:247], v[200:203], v[216:219]
    v_mfma_f32_16x16x32_bf16 v[224:227], a[248:251], v[200:203], v[224:227]
    v_mfma_f32_16x16x32_bf16 v[232:235], a[252:255], v[200:203], v[232:235]
    v_mfma_f32_16x16x32_bf16 v[212:215], a[240:243], v[204:207], v[212:215]
    v_mfma_f32_16x16x32_bf16 v[220:223], a[244:247], v[204:207], v[220:223]
    v_mfma_f32_16x16x32_bf16 v[228:231], a[248:251], v[204:207], v[228:231]
    v_mfma_f32_16x16x32_bf16 v[236:239], a[252:255], v[204:207], v[236:239]
L_fm64:
    s_cmp_lg_u32 s99, 0
    s_cbranch_scc1 L_ofix32
    s_nop 15
    ds_write_b128 v139, v[224:227] offset:0
    ds_write_b128 v139, v[228:231] offset:1024
    ds_write_b128 v139, v[232:235] offset:2048
    ds_write_b128 v139, v[236:239] offset:3072
    s_branch L_odone33
.p2align 8
.fill 4096, 4, 0xbf810000
.section .rodata,"a"
.p2align 6
.amdhsa_kernel gated_mix__linear_attn_block__linear_attn_block__prompt_kernel
  .amdhsa_next_free_vgpr 512
  .amdhsa_next_free_sgpr 102
  .amdhsa_accum_offset 256
  .amdhsa_group_segment_fixed_size 0
  .amdhsa_kernarg_size 80
  .amdhsa_user_sgpr_count 2
  .amdhsa_user_sgpr_kernarg_segment_ptr 1
  .amdhsa_system_sgpr_workgroup_id_x 1
.end_amdhsa_kernel
```
